```python
import torch

def _softmax(x, axis=-1):
    return torch.softmax(x, dim=axis)
def _gelu(x):
    return torch.nn.functional.gelu(x, approximate="tanh")
def _silu(x):
    return torch.nn.functional.silu(x)
def _sigmoid(x):
    return torch.sigmoid(x)
def _layernorm(x, axis=-1, eps=1e-5):
    m = x.mean(dim=axis, keepdim=True)
    v = x.var(dim=axis, keepdim=True, unbiased=False)
    return (x - m) / torch.sqrt(v + eps)
def _scatter_add(tgt, idx, src, axis=0):
    return tgt.clone().index_add_(axis, idx, src)
def _segment_sum(src, seg, n):
    out = torch.zeros((n,) + src.shape[1:], dtype=src.dtype)
    return out.index_add_(0, seg, src)
def _pad(x, pw):
    flat = tuple(v for pair in reversed(pw) for v in pair)
    return torch.nn.functional.pad(x, flat)

kernel_name = 'sequential_preLN__compressed_kv_cla__mixer_token_mlp__prompt'

def setup_inputs():

    _w = (lambda a: (lambda t: t.to(torch.bfloat16) if t.is_floating_point() else t)(torch.as_tensor(a)))
    def _A_setup():
        B, H, Sq, Sk, D, M = 1, 32, 2048, 2048, 128, 512
        Dc = 4 * D
        return {
            "x": _w((lambda *s: torch.randn(*s, dtype=torch.bfloat16) * 0.05)(B, Sq, M)),
            "c_kv": _w((lambda *s: torch.randn(*s, dtype=torch.bfloat16) * 0.2)(B, Sk, Dc)),
            "w_q": _w((lambda *s: torch.randn(*s, dtype=torch.bfloat16) * 3.2)(M, H, D) * (M ** -0.5)),
            "w_uk": _w((lambda *s: torch.randn(*s, dtype=torch.bfloat16) * 6.4)(Dc, H, D) * (Dc ** -0.5)),
            "w_uv": _w((lambda *s: torch.randn(*s, dtype=torch.bfloat16) * 0.2)(Dc, H, D) * (Dc ** -0.5)),
            "w_o": _w((lambda *s: torch.randn(*s, dtype=torch.bfloat16) * 0.2)(H, D, M) * ((H * D) ** -0.5)),
        }
    _A_in = _A_setup()

    def _B_setup():
        B, S, D, F = 1, 2048, 512, 1792
        return {
            "x": _w((lambda *s: torch.randn(*s, dtype=torch.bfloat16) * 0.05)(B, S, D)),
            "w1": _w((lambda *s: torch.randn(*s, dtype=torch.bfloat16) * 0.4)(S, F) * (S ** -0.5)),
            "b1": _w((lambda *s: torch.randn(*s, dtype=torch.bfloat16) * 3.2)(F) * 0.02),
            "w2": _w((lambda *s: torch.randn(*s, dtype=torch.bfloat16) * 0.2)(F, S) * (F ** -0.5)),
            "b2": _w((lambda *s: torch.randn(*s, dtype=torch.bfloat16) * 0.4)(S) * 0.02),
        }
    _B_in = _B_setup()

    return {
        "A_x": _A_in["x"],
        "A_c_kv": _A_in["c_kv"],
        "A_w_q": _A_in["w_q"],
        "A_w_uk": _A_in["w_uk"],
        "A_w_uv": _A_in["w_uv"],
        "A_w_o": _A_in["w_o"],
        "B_x": _B_in["x"],
        "B_w1": _B_in["w1"],
        "B_b1": _B_in["b1"],
        "B_w2": _B_in["w2"],
        "B_b2": _B_in["b2"],
    }

def reference(A_x, A_c_kv, A_w_q, A_w_uk, A_w_uv, A_w_o, B_x, B_w1, B_b1, B_w2, B_b2):
    def _A_ref(x, c_kv, w_q, w_uk, w_uv, w_o):
        B, Sq, M = x.shape[0], x.shape[1], x.shape[2]
        Sk = c_kv.shape[1]
        H, D = w_q.shape[1], w_q.shape[2]
        q = torch.einsum("bqm,mhd->bhqd", x, w_q)
        k = torch.einsum("bkc,chd->bhkd", c_kv, w_uk)
        v = torch.einsum("bkc,chd->bhkd", c_kv, w_uv)
        scores = torch.einsum("bhqd,bhkd->bhqk", q, k) * (D ** -0.5)
        off = Sk - Sq
        qi = torch.arange(Sq)[:, None]
        kj = torch.arange(Sk)[None, :]
        cmask = kj <= (qi + off)
        scores = torch.where(cmask[None, None], scores, -1e9)
        p = _softmax(scores, axis=-1)
        ctx = torch.einsum("bhqk,bhkd->bhqd", p, v)
        return torch.einsum("bhqd,hdm->bqm", ctx, w_o)

    def _B_ref(x, w1, b1, w2, b2):
        B, S, D = x.shape
        h = _layernorm(x, axis=-1)
        u = torch.einsum("bsd,sf->bdf", h, w1) + b1
        u = _gelu(u)
        y = torch.einsum("bdf,fs->bds", u, w2) + b2
        return (lambda x, *d: x.permute(*d))(y, 0, 2, 1)

    x = A_x
    h = x + _A_ref(_layernorm(x, axis=-1), A_c_kv, A_w_q, A_w_uk, A_w_uv, A_w_o)
    h2 = h + _B_ref(_layernorm(h, axis=-1), B_w1, B_b1, B_w2, B_b2)
    return h2
```

```asm
; @launch kernel=kvproj_kernel grid=(256,1,1) block=(512,1,1) lds=147456
; @launch kernel=attn_kernel grid=(256,1,1) block=(512,1,1) lds=163840
; @launch kernel=oproj_kernel grid=(256,1,1) block=(512,1,1) lds=131072
; @launch kernel=red_kernel grid=(512,1,1) block=(256,1,1) lds=0
; @launch kernel=mlpa_kernel grid=(224,1,1) block=(512,1,1) lds=131072
; @launch kernel=mlpb_kernel grid=(256,1,1) block=(512,1,1) lds=131072
.amdgcn_target "amdgcn-amd-amdhsa--gfx950"
.text
.globl kvproj_kernel
.p2align 8
.type kvproj_kernel,@function
kvproj_kernel:
    s_cmp_ge_u32 s2, 256
    s_cbranch_scc1 .Lkvproj_end_1
    v_and_b32 v1, 63, v0
    v_lshrrev_b32 v2, 6, v0
    s_nop 0
    v_readfirstlane_b32 s3, v2
    s_load_dwordx2 s[8:9], s[0:1], 8
    s_load_dwordx2 s[12:13], s[0:1], 24
    s_load_dwordx2 s[16:17], s[0:1], 32
    s_load_dwordx2 s[20:21], s[0:1], 104
    s_load_dwordx2 s[24:25], s[0:1], 104
    s_load_dwordx2 s[28:29], s[0:1], 0
    s_load_dwordx2 s[32:33], s[0:1], 104
    s_load_dwordx2 s[48:49], s[0:1], 16
    s_and_b32 s36, s2, 7
    s_lshl_b32 s36, s36, 2
    s_bfe_u32 s37, s2, 0x20003
    s_add_u32 s36, s36, s37
    s_lshr_b32 s37, s2, 5
    s_lshr_b32 s38, s3, 2
    s_and_b32 s39, s3, 3
    v_lshl_add_u32 v3, v2, 2, 0
    v_lshrrev_b32 v8, 3, v1
    v_lshl_add_u32 v8, v3, 3, v8
    v_and_b32 v9, 7, v1
    v_bfe_u32 v10, v8, 1, 3
    v_xor_b32 v9, v9, v10
    v_lshlrev_b32 v9, 4, v9
    v_lshl_add_u32 v4, v8, 10, v9
    v_lshl_add_u32 v3, v2, 2, 1
    v_lshrrev_b32 v8, 3, v1
    v_lshl_add_u32 v8, v3, 3, v8
    v_and_b32 v9, 7, v1
    v_bfe_u32 v10, v8, 1, 3
    v_xor_b32 v9, v9, v10
    v_lshlrev_b32 v9, 4, v9
    v_lshl_add_u32 v5, v8, 10, v9
    v_lshl_add_u32 v3, v2, 2, 2
    v_lshrrev_b32 v8, 3, v1
    v_lshl_add_u32 v8, v3, 3, v8
    v_and_b32 v9, 7, v1
    v_bfe_u32 v10, v8, 1, 3
    v_xor_b32 v9, v9, v10
    v_lshlrev_b32 v9, 4, v9
    v_lshl_add_u32 v6, v8, 10, v9
    v_lshl_add_u32 v3, v2, 2, 3
    v_lshrrev_b32 v8, 3, v1
    v_lshl_add_u32 v8, v3, 3, v8
    v_and_b32 v9, 7, v1
    v_bfe_u32 v10, v8, 1, 3
    v_xor_b32 v9, v9, v10
    v_lshlrev_b32 v9, 4, v9
    v_lshl_add_u32 v7, v8, 10, v9
    v_lshl_add_u32 v3, v2, 1, 0
    v_lshrrev_b32 v10, 4, v1
    v_and_b32 v11, 15, v1
    v_mul_u32_u24 v12, 4, v3
    v_add_u32 v10, v10, v12
    v_and_b32 v12, 3, v10
    v_lshlrev_b32 v12, 2, v12
    v_xor_b32 v11, v11, v12
    v_lshlrev_b32 v11, 4, v11
    s_mov_b32 s60, 8192
    v_mul_lo_u32 v8, s60, v10
    v_add_u32 v8, v8, v11
    v_lshl_add_u32 v3, v2, 1, 1
    v_lshrrev_b32 v10, 4, v1
    v_and_b32 v11, 15, v1
    v_mul_u32_u24 v12, 4, v3
    v_add_u32 v10, v10, v12
    v_and_b32 v12, 3, v10
    v_lshlrev_b32 v12, 2, v12
    v_xor_b32 v11, v11, v12
    v_lshlrev_b32 v11, 4, v11
    s_mov_b32 s60, 8192
    v_mul_lo_u32 v9, s60, v10
    v_add_u32 v9, v9, v11
    s_lshl_b32 s41, s37, 18
    s_lshl_b32 s42, s36, 8
    s_lshl_b32 s43, s3, 12
    s_lshl_b32 s44, s3, 11
    s_add_u32 s44, s44, 32768
    s_lshl_b32 s40, s2, 3
    s_add_u32 s40, s40, s3
    s_lshl_b32 s40, s40, 10
    v_lshlrev_b32 v10, 4, v1
    s_waitcnt lgkmcnt(0)
    s_and_b32 s9, s9, 0xffff
    s_mov_b32 s10, 0x200000
    s_mov_b32 s11, 0x20000
    s_and_b32 s13, s13, 0xffff
    s_mov_b32 s14, 0x400000
    s_mov_b32 s15, 0x20000
    s_and_b32 s17, s17, 0xffff
    s_mov_b32 s18, 0x400000
    s_mov_b32 s19, 0x20000
    s_add_u32 s20, s20, 0x1200000
    s_addc_u32 s21, s21, 0
    s_and_b32 s21, s21, 0xffff
    s_mov_b32 s22, 0x1000000
    s_mov_b32 s23, 0x20000
    s_add_u32 s24, s24, 0x2200000
    s_addc_u32 s25, s25, 0
    s_and_b32 s25, s25, 0xffff
    s_mov_b32 s26, 0x1000000
    s_mov_b32 s27, 0x20000
    s_and_b32 s29, s29, 0xffff
    s_mov_b32 s30, 0x200000
    s_mov_b32 s31, 0x20000
    s_and_b32 s33, s33, 0xffff
    s_mov_b32 s34, 0x200000
    s_mov_b32 s35, 0x20000
    s_and_b32 s49, s49, 0xffff
    s_mov_b32 s50, 0x400000
    s_mov_b32 s51, 0x20000
    s_mul_i32 s63, s2, 512
    v_add_u32 v216, s63, v0
    v_lshrrev_b32 v216, 2, v216
    v_lshlrev_b32 v216, 7, v216
    s_add_u32 m0, s43, 0x0
    s_nop 0
    buffer_load_dwordx4 v4, s[8:11], s41 offen lds
    s_add_u32 m0, s43, 0x400
    s_nop 0
    buffer_load_dwordx4 v5, s[8:11], s41 offen lds
    s_add_u32 m0, s43, 0x800
    s_nop 0
    buffer_load_dwordx4 v6, s[8:11], s41 offen lds
    s_add_u32 m0, s43, 0xc00
    s_nop 0
    buffer_load_dwordx4 v7, s[8:11], s41 offen lds
    s_add_u32 m0, s44, 0x0
    s_nop 0
    buffer_load_dwordx4 v8, s[12:15], s42 offen lds
    s_add_u32 m0, s44, 0x400
    s_nop 0
    buffer_load_dwordx4 v9, s[12:15], s42 offen lds
    s_add_u32 s41, s41, 128
    s_add_u32 s42, s42, 0x80000
    s_add_u32 m0, s43, 0xc000
    s_nop 0
    buffer_load_dwordx4 v4, s[8:11], s41 offen lds
    s_add_u32 m0, s43, 0xc400
    s_nop 0
    buffer_load_dwordx4 v5, s[8:11], s41 offen lds
    s_add_u32 m0, s43, 0xc800
    s_nop 0
    buffer_load_dwordx4 v6, s[8:11], s41 offen lds
    s_add_u32 m0, s43, 0xcc00
    s_nop 0
    buffer_load_dwordx4 v7, s[8:11], s41 offen lds
    s_add_u32 m0, s44, 0xc000
    s_nop 0
    buffer_load_dwordx4 v8, s[12:15], s42 offen lds
    s_add_u32 m0, s44, 0xc400
    s_nop 0
    buffer_load_dwordx4 v9, s[12:15], s42 offen lds
    s_add_u32 s41, s41, 128
    s_add_u32 s42, s42, 0x80000
    s_lshl_b32 s58, s37, 8
    s_and_b32 s59, s36, 3
    s_lshl_b32 s59, s59, 6
    s_add_u32 s58, s58, s59
    s_lshl_b32 s59, s3, 3
    s_add_u32 s58, s58, s59
    s_lshl_b32 s58, s58, 10
    v_lshlrev_b32 v213, 10, v1
    v_add_u32 v213, s58, v213
    v_cmp_gt_u32 vcc, 8, v1
    v_mov_b32 v215, 0x7f000000
    v_cndmask_b32 v213, v215, v213, vcc
    s_lshl_b32 s58, s37, 3
    s_add_u32 s58, s58, s3
    s_lshl_b32 s58, s58, 13
    s_lshl_b32 s59, s36, 8
    s_add_u32 s58, s58, s59
    v_lshlrev_b32 v214, 7, v1
    v_add_u32 v214, s58, v214
    v_cmp_gt_u32 vcc, 2, v1
    v_cndmask_b32 v214, v215, v214, vcc
    s_mov_b32 s58, 256
    buffer_load_dword v215, v213, s[8:11], s58 offen
    s_mov_b32 s59, 0x100000
    buffer_load_dword v215, v214, s[12:15], s59 offen
    s_mov_b32 s58, 384
    buffer_load_dword v215, v213, s[8:11], s58 offen
    s_mov_b32 s59, 0x180000
    buffer_load_dword v215, v214, s[12:15], s59 offen
    buffer_load_dwordx4 v[12:15], v10, s[28:31], s40 offen
    v_and_b32 v218, 31, v1
    v_lshrrev_b32 v219, 5, v1
    v_add_u32 v219, 0, v219
    v_bfe_u32 v220, v218, 1, 3
    v_xor_b32 v219, v219, v220
    v_lshlrev_b32 v219, 4, v219
    v_lshl_add_u32 v16, v218, 7, v219
    s_lshl_b32 s45, s39, 13
    v_add_u32 v16, s45, v16
    v_add_u32 v17, 0x10000, v16
    v_add_u32 v18, 0x20000, v16
    v_and_b32 v218, 31, v1
    v_lshrrev_b32 v219, 5, v1
    v_add_u32 v219, 2, v219
    v_bfe_u32 v220, v218, 1, 3
    v_xor_b32 v219, v219, v220
    v_lshlrev_b32 v219, 4, v219
    v_lshl_add_u32 v19, v218, 7, v219
    s_lshl_b32 s45, s39, 13
    v_add_u32 v19, s45, v19
    v_add_u32 v20, 0x10000, v19
    v_add_u32 v21, 0x20000, v19
    v_and_b32 v218, 31, v1
    v_lshrrev_b32 v219, 5, v1
    v_add_u32 v219, 4, v219
    v_bfe_u32 v220, v218, 1, 3
    v_xor_b32 v219, v219, v220
    v_lshlrev_b32 v219, 4, v219
    v_lshl_add_u32 v22, v218, 7, v219
    s_lshl_b32 s45, s39, 13
    v_add_u32 v22, s45, v22
    v_add_u32 v23, 0x10000, v22
    v_add_u32 v24, 0x20000, v22
    v_and_b32 v218, 31, v1
    v_lshrrev_b32 v219, 5, v1
    v_add_u32 v219, 6, v219
    v_bfe_u32 v220, v218, 1, 3
    v_xor_b32 v219, v219, v220
    v_lshlrev_b32 v219, 4, v219
    v_lshl_add_u32 v25, v218, 7, v219
    s_lshl_b32 s45, s39, 13
    v_add_u32 v25, s45, v25
    v_add_u32 v26, 0x10000, v25
    v_add_u32 v27, 0x20000, v25
    v_bfe_u32 v218, v1, 2, 2
    v_lshrrev_b32 v219, 5, v1
    v_lshlrev_b32 v219, 3, v219
    v_add_u32 v219, v219, v218
    v_mul_u32_u24 v28, 256, v219
    v_xor_b32 v218, 0, v218
    v_lshlrev_b32 v218, 6, v218
    v_add_u32 v28, v28, v218
    v_bfe_u32 v218, v1, 4, 1
    v_lshlrev_b32 v218, 5, v218
    v_add_u32 v28, v28, v218
    v_and_b32 v218, 3, v1
    v_lshlrev_b32 v218, 3, v218
    v_add_u32 v28, v28, v218
    s_lshl_b32 s45, s38, 7
    v_xor_b32 v28, s45, v28
    v_add_u32 v28, 32768, v28
    v_add_u32 v29, 0x10000, v28
    v_add_u32 v30, 0x20000, v28
    v_bfe_u32 v218, v1, 2, 2
    v_lshrrev_b32 v219, 5, v1
    v_lshlrev_b32 v219, 3, v219
    v_add_u32 v219, v219, v218
    v_mul_u32_u24 v31, 256, v219
    v_xor_b32 v218, 1, v218
    v_lshlrev_b32 v218, 6, v218
    v_add_u32 v31, v31, v218
    v_bfe_u32 v218, v1, 4, 1
    v_lshlrev_b32 v218, 5, v218
    v_add_u32 v31, v31, v218
    v_and_b32 v218, 3, v1
    v_lshlrev_b32 v218, 3, v218
    v_add_u32 v31, v31, v218
    s_lshl_b32 s45, s38, 7
    v_xor_b32 v31, s45, v31
    v_add_u32 v31, 32768, v31
    v_add_u32 v32, 0x10000, v31
    v_add_u32 v33, 0x20000, v31
    v_mov_b32 v36, 0
    v_mov_b32 v37, 0
    v_mov_b32 v38, 0
    v_mov_b32 v39, 0
    v_mov_b32 v40, 0
    v_mov_b32 v41, 0
    v_mov_b32 v42, 0
    v_mov_b32 v43, 0
    v_mov_b32 v44, 0
    v_mov_b32 v45, 0
    v_mov_b32 v46, 0
    v_mov_b32 v47, 0
    v_mov_b32 v48, 0
    v_mov_b32 v49, 0
    v_mov_b32 v50, 0
    v_mov_b32 v51, 0
    v_mov_b32 v52, 0
    v_mov_b32 v53, 0
    v_mov_b32 v54, 0
    v_mov_b32 v55, 0
    v_mov_b32 v56, 0
    v_mov_b32 v57, 0
    v_mov_b32 v58, 0
    v_mov_b32 v59, 0
    v_mov_b32 v60, 0
    v_mov_b32 v61, 0
    v_mov_b32 v62, 0
    v_mov_b32 v63, 0
    v_mov_b32 v64, 0
    v_mov_b32 v65, 0
    v_mov_b32 v66, 0
    v_mov_b32 v67, 0
    v_mov_b32 v68, 0
    v_mov_b32 v69, 0
    v_mov_b32 v70, 0
    v_mov_b32 v71, 0
    v_mov_b32 v72, 0
    v_mov_b32 v73, 0
    v_mov_b32 v74, 0
    v_mov_b32 v75, 0
    v_mov_b32 v76, 0
    v_mov_b32 v77, 0
    v_mov_b32 v78, 0
    v_mov_b32 v79, 0
    v_mov_b32 v80, 0
    v_mov_b32 v81, 0
    v_mov_b32 v82, 0
    v_mov_b32 v83, 0
    v_mov_b32 v84, 0
    v_mov_b32 v85, 0
    v_mov_b32 v86, 0
    v_mov_b32 v87, 0
    v_mov_b32 v88, 0
    v_mov_b32 v89, 0
    v_mov_b32 v90, 0
    v_mov_b32 v91, 0
    v_mov_b32 v92, 0
    v_mov_b32 v93, 0
    v_mov_b32 v94, 0
    v_mov_b32 v95, 0
    v_mov_b32 v96, 0
    v_mov_b32 v97, 0
    v_mov_b32 v98, 0
    v_mov_b32 v99, 0
    v_mov_b32 v100, 0
    v_mov_b32 v101, 0
    v_mov_b32 v102, 0
    v_mov_b32 v103, 0
    v_mov_b32 v104, 0
    v_mov_b32 v105, 0
    v_mov_b32 v106, 0
    v_mov_b32 v107, 0
    v_mov_b32 v108, 0
    v_mov_b32 v109, 0
    v_mov_b32 v110, 0
    v_mov_b32 v111, 0
    v_mov_b32 v112, 0
    v_mov_b32 v113, 0
    v_mov_b32 v114, 0
    v_mov_b32 v115, 0
    v_mov_b32 v116, 0
    v_mov_b32 v117, 0
    v_mov_b32 v118, 0
    v_mov_b32 v119, 0
    v_mov_b32 v120, 0
    v_mov_b32 v121, 0
    v_mov_b32 v122, 0
    v_mov_b32 v123, 0
    v_mov_b32 v124, 0
    v_mov_b32 v125, 0
    v_mov_b32 v126, 0
    v_mov_b32 v127, 0
    v_mov_b32 v128, 0
    v_mov_b32 v129, 0
    v_mov_b32 v130, 0
    v_mov_b32 v131, 0
    v_mov_b32 v132, 0
    v_mov_b32 v133, 0
    v_mov_b32 v134, 0
    v_mov_b32 v135, 0
    v_mov_b32 v136, 0
    v_mov_b32 v137, 0
    v_mov_b32 v138, 0
    v_mov_b32 v139, 0
    v_mov_b32 v140, 0
    v_mov_b32 v141, 0
    v_mov_b32 v142, 0
    v_mov_b32 v143, 0
    v_mov_b32 v144, 0
    v_mov_b32 v145, 0
    v_mov_b32 v146, 0
    v_mov_b32 v147, 0
    v_mov_b32 v148, 0
    v_mov_b32 v149, 0
    v_mov_b32 v150, 0
    v_mov_b32 v151, 0
    v_mov_b32 v152, 0
    v_mov_b32 v153, 0
    v_mov_b32 v154, 0
    v_mov_b32 v155, 0
    v_mov_b32 v156, 0
    v_mov_b32 v157, 0
    v_mov_b32 v158, 0
    v_mov_b32 v159, 0
    v_mov_b32 v160, 0
    v_mov_b32 v161, 0
    v_mov_b32 v162, 0
    v_mov_b32 v163, 0
    v_lshlrev_b32 v212, 4, v1
    s_lshl_b32 s46, s36, 19
    s_lshl_b32 s47, s37, 16
    s_add_u32 s46, s46, s47
    s_lshl_b32 s47, s39, 14
    s_add_u32 s46, s46, s47
    s_lshl_b32 s47, s38, 11
    s_add_u32 s57, s46, s47
    s_add_u32 s56, s57, s47
    s_waitcnt vmcnt(11) lgkmcnt(0)
    s_barrier
    ds_read_b64_tr_b16 v[164:165], v28 offset:0
    ds_read_b64_tr_b16 v[166:167], v28 offset:1024
    ds_read_b64_tr_b16 v[168:169], v31 offset:0
    ds_read_b64_tr_b16 v[170:171], v31 offset:1024
    ds_read_b128 v[172:175], v16 offset:0
    ds_read_b128 v[176:179], v16 offset:4096
    s_waitcnt lgkmcnt(0)
    v_mfma_f32_32x32x16_bf16 v[36:51], v[164:167], v[172:175], v[36:51]
    ds_read_b64_tr_b16 v[180:181], v28 offset:4096
    ds_read_b64_tr_b16 v[182:183], v28 offset:5120
    v_mfma_f32_32x32x16_bf16 v[52:67], v[164:167], v[176:179], v[52:67]
    ds_read_b64_tr_b16 v[184:185], v31 offset:4096
    ds_read_b64_tr_b16 v[186:187], v31 offset:5120
    s_add_u32 m0, s43, 0x18000
    s_nop 0
    buffer_load_dwordx4 v4, s[8:11], s41 offen lds
    v_mfma_f32_32x32x16_bf16 v[68:83], v[168:171], v[172:175], v[68:83]
    ds_read_b128 v[188:191], v19 offset:0
    ds_read_b128 v[192:195], v19 offset:4096
    s_add_u32 m0, s43, 0x18400
    s_nop 0
    buffer_load_dwordx4 v5, s[8:11], s41 offen lds
    v_mfma_f32_32x32x16_bf16 v[84:99], v[168:171], v[176:179], v[84:99]
    s_add_u32 m0, s43, 0x18800
    s_nop 0
    buffer_load_dwordx4 v6, s[8:11], s41 offen lds
    s_waitcnt lgkmcnt(0)
    v_mfma_f32_32x32x16_bf16 v[36:51], v[180:183], v[188:191], v[36:51]
    ds_read_b64_tr_b16 v[164:165], v28 offset:8192
    ds_read_b64_tr_b16 v[166:167], v28 offset:9216
    v_mfma_f32_32x32x16_bf16 v[52:67], v[180:183], v[192:195], v[52:67]
    ds_read_b64_tr_b16 v[168:169], v31 offset:8192
    ds_read_b64_tr_b16 v[170:171], v31 offset:9216
    s_add_u32 m0, s43, 0x18c00
    s_nop 0
    buffer_load_dwordx4 v7, s[8:11], s41 offen lds
    v_mfma_f32_32x32x16_bf16 v[68:83], v[184:187], v[188:191], v[68:83]
    ds_read_b128 v[172:175], v22 offset:0
    ds_read_b128 v[176:179], v22 offset:4096
    s_add_u32 m0, s44, 0x18000
    s_nop 0
    buffer_load_dwordx4 v8, s[12:15], s42 offen lds
    v_mfma_f32_32x32x16_bf16 v[84:99], v[184:187], v[192:195], v[84:99]
    s_add_u32 m0, s44, 0x18400
    s_nop 0
    buffer_load_dwordx4 v9, s[12:15], s42 offen lds
    s_waitcnt lgkmcnt(0)
    v_mfma_f32_32x32x16_bf16 v[36:51], v[164:167], v[172:175], v[36:51]
    ds_read_b64_tr_b16 v[180:181], v28 offset:12288
    ds_read_b64_tr_b16 v[182:183], v28 offset:13312
    v_mfma_f32_32x32x16_bf16 v[52:67], v[164:167], v[176:179], v[52:67]
    ds_read_b64_tr_b16 v[184:185], v31 offset:12288
    ds_read_b64_tr_b16 v[186:187], v31 offset:13312
    s_add_u32 s41, s41, 128
    s_add_u32 s42, s42, 0x80000
    v_mfma_f32_32x32x16_bf16 v[68:83], v[168:171], v[172:175], v[68:83]
    ds_read_b128 v[188:191], v25 offset:0
    ds_read_b128 v[192:195], v25 offset:4096
    s_mov_b32 s58, 512
    buffer_load_dword v215, v213, s[8:11], s58 offen
    v_mfma_f32_32x32x16_bf16 v[84:99], v[168:171], v[176:179], v[84:99]
    s_mov_b32 s59, 0x200000
    buffer_load_dword v215, v214, s[12:15], s59 offen
    s_waitcnt vmcnt(13) lgkmcnt(0)
    s_barrier
    v_mfma_f32_32x32x16_bf16 v[36:51], v[180:183], v[188:191], v[36:51]
    ds_read_b64_tr_b16 v[164:165], v28 offset:49152
    ds_read_b64_tr_b16 v[166:167], v28 offset:50176
    v_mfma_f32_32x32x16_bf16 v[52:67], v[180:183], v[192:195], v[52:67]
    ds_read_b64_tr_b16 v[168:169], v31 offset:49152
    ds_read_b64_tr_b16 v[170:171], v31 offset:50176
    s_add_u32 m0, s43, 0x0
    s_nop 0
    buffer_load_dwordx4 v4, s[8:11], s41 offen lds
    v_mfma_f32_32x32x16_bf16 v[68:83], v[184:187], v[188:191], v[68:83]
    ds_read_b128 v[172:175], v16 offset:49152
    ds_read_b128 v[176:179], v16 offset:53248
    s_add_u32 m0, s43, 0x400
    s_nop 0
    buffer_load_dwordx4 v5, s[8:11], s41 offen lds
    v_mfma_f32_32x32x16_bf16 v[84:99], v[184:187], v[192:195], v[84:99]
    s_add_u32 m0, s43, 0x800
    s_nop 0
    buffer_load_dwordx4 v6, s[8:11], s41 offen lds
    s_waitcnt lgkmcnt(0)
    v_mfma_f32_32x32x16_bf16 v[36:51], v[164:167], v[172:175], v[36:51]
    ds_read_b64_tr_b16 v[180:181], v28 offset:53248
    ds_read_b64_tr_b16 v[182:183], v28 offset:54272
    v_mfma_f32_32x32x16_bf16 v[52:67], v[164:167], v[176:179], v[52:67]
    ds_read_b64_tr_b16 v[184:185], v31 offset:53248
    ds_read_b64_tr_b16 v[186:187], v31 offset:54272
    s_add_u32 m0, s43, 0xc00
    s_nop 0
    buffer_load_dwordx4 v7, s[8:11], s41 offen lds
    v_mfma_f32_32x32x16_bf16 v[68:83], v[168:171], v[172:175], v[68:83]
    ds_read_b128 v[188:191], v19 offset:49152
    ds_read_b128 v[192:195], v19 offset:53248
    s_add_u32 m0, s44, 0x0
    s_nop 0
    buffer_load_dwordx4 v8, s[12:15], s42 offen lds
    v_mfma_f32_32x32x16_bf16 v[84:99], v[168:171], v[176:179], v[84:99]
    s_add_u32 m0, s44, 0x400
    s_nop 0
    buffer_load_dwordx4 v9, s[12:15], s42 offen lds
    s_waitcnt lgkmcnt(0)
    v_mfma_f32_32x32x16_bf16 v[36:51], v[180:183], v[188:191], v[36:51]
    ds_read_b64_tr_b16 v[164:165], v28 offset:57344
    ds_read_b64_tr_b16 v[166:167], v28 offset:58368
    v_mfma_f32_32x32x16_bf16 v[52:67], v[180:183], v[192:195], v[52:67]
    ds_read_b64_tr_b16 v[168:169], v31 offset:57344
    ds_read_b64_tr_b16 v[170:171], v31 offset:58368
    s_add_u32 s41, s41, 128
    s_add_u32 s42, s42, 0x80000
    v_mfma_f32_32x32x16_bf16 v[68:83], v[184:187], v[188:191], v[68:83]
    ds_read_b128 v[172:175], v22 offset:49152
    ds_read_b128 v[176:179], v22 offset:53248
    s_mov_b32 s58, 640
    buffer_load_dword v215, v213, s[8:11], s58 offen
    v_mfma_f32_32x32x16_bf16 v[84:99], v[184:187], v[192:195], v[84:99]
    s_mov_b32 s59, 0x280000
    buffer_load_dword v215, v214, s[12:15], s59 offen
    s_waitcnt lgkmcnt(0)
    v_mfma_f32_32x32x16_bf16 v[36:51], v[164:167], v[172:175], v[36:51]
    ds_read_b64_tr_b16 v[180:181], v28 offset:61440
    ds_read_b64_tr_b16 v[182:183], v28 offset:62464
    v_mfma_f32_32x32x16_bf16 v[52:67], v[164:167], v[176:179], v[52:67]
    ds_read_b64_tr_b16 v[184:185], v31 offset:61440
    ds_read_b64_tr_b16 v[186:187], v31 offset:62464
    v_mfma_f32_32x32x16_bf16 v[68:83], v[168:171], v[172:175], v[68:83]
    ds_read_b128 v[188:191], v25 offset:49152
    ds_read_b128 v[192:195], v25 offset:53248
    v_mfma_f32_32x32x16_bf16 v[84:99], v[168:171], v[176:179], v[84:99]
    s_waitcnt vmcnt(10) lgkmcnt(0)
    s_barrier
    v_mfma_f32_32x32x16_bf16 v[36:51], v[180:183], v[188:191], v[36:51]
    ds_read_b64_tr_b16 v[164:165], v29 offset:32768
    ds_read_b64_tr_b16 v[166:167], v29 offset:33792
    v_mfma_f32_32x32x16_bf16 v[52:67], v[180:183], v[192:195], v[52:67]
    ds_read_b64_tr_b16 v[168:169], v32 offset:32768
    ds_read_b64_tr_b16 v[170:171], v32 offset:33792
    s_add_u32 m0, s43, 0xc000
    s_nop 0
    buffer_load_dwordx4 v4, s[8:11], s41 offen lds
    v_mfma_f32_32x32x16_bf16 v[68:83], v[184:187], v[188:191], v[68:83]
    ds_read_b128 v[172:175], v17 offset:32768
    ds_read_b128 v[176:179], v17 offset:36864
    s_add_u32 m0, s43, 0xc400
    s_nop 0
    buffer_load_dwordx4 v5, s[8:11], s41 offen lds
    v_mfma_f32_32x32x16_bf16 v[84:99], v[184:187], v[192:195], v[84:99]
    s_add_u32 m0, s43, 0xc800
    s_nop 0
    buffer_load_dwordx4 v6, s[8:11], s41 offen lds
    s_waitcnt lgkmcnt(0)
    v_mfma_f32_32x32x16_bf16 v[36:51], v[164:167], v[172:175], v[36:51]
    ds_read_b64_tr_b16 v[180:181], v29 offset:36864
    ds_read_b64_tr_b16 v[182:183], v29 offset:37888
    v_mfma_f32_32x32x16_bf16 v[52:67], v[164:167], v[176:179], v[52:67]
    ds_read_b64_tr_b16 v[184:185], v32 offset:36864
    ds_read_b64_tr_b16 v[186:187], v32 offset:37888
    s_add_u32 m0, s43, 0xcc00
    s_nop 0
    buffer_load_dwordx4 v7, s[8:11], s41 offen lds
    v_mfma_f32_32x32x16_bf16 v[68:83], v[168:171], v[172:175], v[68:83]
    ds_read_b128 v[188:191], v20 offset:32768
    ds_read_b128 v[192:195], v20 offset:36864
    s_add_u32 m0, s44, 0xc000
    s_nop 0
    buffer_load_dwordx4 v8, s[12:15], s42 offen lds
    v_mfma_f32_32x32x16_bf16 v[84:99], v[168:171], v[176:179], v[84:99]
    s_add_u32 m0, s44, 0xc400
    s_nop 0
    buffer_load_dwordx4 v9, s[12:15], s42 offen lds
    s_waitcnt lgkmcnt(0)
    v_mfma_f32_32x32x16_bf16 v[36:51], v[180:183], v[188:191], v[36:51]
    ds_read_b64_tr_b16 v[164:165], v29 offset:40960
    ds_read_b64_tr_b16 v[166:167], v29 offset:41984
    v_mfma_f32_32x32x16_bf16 v[52:67], v[180:183], v[192:195], v[52:67]
    ds_read_b64_tr_b16 v[168:169], v32 offset:40960
    ds_read_b64_tr_b16 v[170:171], v32 offset:41984
    s_add_u32 s41, s41, 128
    s_add_u32 s42, s42, 0x80000
    v_mfma_f32_32x32x16_bf16 v[68:83], v[184:187], v[188:191], v[68:83]
    ds_read_b128 v[172:175], v23 offset:32768
    ds_read_b128 v[176:179], v23 offset:36864
    s_mov_b32 s58, 768
    buffer_load_dword v215, v213, s[8:11], s58 offen
    v_mfma_f32_32x32x16_bf16 v[84:99], v[184:187], v[192:195], v[84:99]
    s_mov_b32 s59, 0x300000
    buffer_load_dword v215, v214, s[12:15], s59 offen
    s_waitcnt lgkmcnt(0)
    v_mfma_f32_32x32x16_bf16 v[36:51], v[164:167], v[172:175], v[36:51]
    ds_read_b64_tr_b16 v[180:181], v29 offset:45056
    ds_read_b64_tr_b16 v[182:183], v29 offset:46080
    v_mfma_f32_32x32x16_bf16 v[52:67], v[164:167], v[176:179], v[52:67]
    ds_read_b64_tr_b16 v[184:185], v32 offset:45056
    ds_read_b64_tr_b16 v[186:187], v32 offset:46080
    v_mfma_f32_32x32x16_bf16 v[68:83], v[168:171], v[172:175], v[68:83]
    ds_read_b128 v[188:191], v26 offset:32768
    ds_read_b128 v[192:195], v26 offset:36864
    v_mfma_f32_32x32x16_bf16 v[84:99], v[168:171], v[176:179], v[84:99]
    s_waitcnt vmcnt(10) lgkmcnt(0)
    s_barrier
    v_mfma_f32_32x32x16_bf16 v[36:51], v[180:183], v[188:191], v[36:51]
    ds_read_b64_tr_b16 v[164:165], v28 offset:0
    ds_read_b64_tr_b16 v[166:167], v28 offset:1024
    v_mfma_f32_32x32x16_bf16 v[52:67], v[180:183], v[192:195], v[52:67]
    ds_read_b64_tr_b16 v[168:169], v31 offset:0
    ds_read_b64_tr_b16 v[170:171], v31 offset:1024
    s_add_u32 m0, s43, 0x18000
    s_nop 0
    buffer_load_dwordx4 v4, s[8:11], s41 offen lds
    v_mfma_f32_32x32x16_bf16 v[68:83], v[184:187], v[188:191], v[68:83]
    ds_read_b128 v[172:175], v16 offset:0
    ds_read_b128 v[176:179], v16 offset:4096
    s_add_u32 m0, s43, 0x18400
    s_nop 0
    buffer_load_dwordx4 v5, s[8:11], s41 offen lds
    v_mfma_f32_32x32x16_bf16 v[84:99], v[184:187], v[192:195], v[84:99]
    s_add_u32 m0, s43, 0x18800
    s_nop 0
    buffer_load_dwordx4 v6, s[8:11], s41 offen lds
    s_waitcnt lgkmcnt(0)
    v_mfma_f32_32x32x16_bf16 v[36:51], v[164:167], v[172:175], v[36:51]
    ds_read_b64_tr_b16 v[180:181], v28 offset:4096
    ds_read_b64_tr_b16 v[182:183], v28 offset:5120
    v_mfma_f32_32x32x16_bf16 v[52:67], v[164:167], v[176:179], v[52:67]
    ds_read_b64_tr_b16 v[184:185], v31 offset:4096
    ds_read_b64_tr_b16 v[186:187], v31 offset:5120
    s_add_u32 m0, s43, 0x18c00
    s_nop 0
    buffer_load_dwordx4 v7, s[8:11], s41 offen lds
    v_mfma_f32_32x32x16_bf16 v[68:83], v[168:171], v[172:175], v[68:83]
    ds_read_b128 v[188:191], v19 offset:0
    ds_read_b128 v[192:195], v19 offset:4096
    s_add_u32 m0, s44, 0x18000
    s_nop 0
    buffer_load_dwordx4 v8, s[12:15], s42 offen lds
    v_mfma_f32_32x32x16_bf16 v[84:99], v[168:171], v[176:179], v[84:99]
    s_add_u32 m0, s44, 0x18400
    s_nop 0
    buffer_load_dwordx4 v9, s[12:15], s42 offen lds
    s_waitcnt lgkmcnt(0)
    v_mfma_f32_32x32x16_bf16 v[36:51], v[180:183], v[188:191], v[36:51]
    ds_read_b64_tr_b16 v[164:165], v28 offset:8192
    ds_read_b64_tr_b16 v[166:167], v28 offset:9216
    v_mfma_f32_32x32x16_bf16 v[52:67], v[180:183], v[192:195], v[52:67]
    ds_read_b64_tr_b16 v[168:169], v31 offset:8192
    ds_read_b64_tr_b16 v[170:171], v31 offset:9216
    s_add_u32 s41, s41, 128
    s_add_u32 s42, s42, 0x80000
    v_mfma_f32_32x32x16_bf16 v[68:83], v[184:187], v[188:191], v[68:83]
    ds_read_b128 v[172:175], v22 offset:0
    ds_read_b128 v[176:179], v22 offset:4096
    s_mov_b32 s58, 896
    buffer_load_dword v215, v213, s[8:11], s58 offen
    v_mfma_f32_32x32x16_bf16 v[84:99], v[184:187], v[192:195], v[84:99]
    s_mov_b32 s59, 0x380000
    buffer_load_dword v215, v214, s[12:15], s59 offen
    s_waitcnt lgkmcnt(0)
    v_mfma_f32_32x32x16_bf16 v[36:51], v[164:167], v[172:175], v[36:51]
    ds_read_b64_tr_b16 v[180:181], v28 offset:12288
    ds_read_b64_tr_b16 v[182:183], v28 offset:13312
    v_mfma_f32_32x32x16_bf16 v[52:67], v[164:167], v[176:179], v[52:67]
    ds_read_b64_tr_b16 v[184:185], v31 offset:12288
    ds_read_b64_tr_b16 v[186:187], v31 offset:13312
    v_mfma_f32_32x32x16_bf16 v[68:83], v[168:171], v[172:175], v[68:83]
    ds_read_b128 v[188:191], v25 offset:0
    ds_read_b128 v[192:195], v25 offset:4096
    v_mfma_f32_32x32x16_bf16 v[84:99], v[168:171], v[176:179], v[84:99]
    s_waitcnt vmcnt(10) lgkmcnt(0)
    s_barrier
    v_mfma_f32_32x32x16_bf16 v[36:51], v[180:183], v[188:191], v[36:51]
    ds_read_b64_tr_b16 v[164:165], v28 offset:49152
    ds_read_b64_tr_b16 v[166:167], v28 offset:50176
    v_mfma_f32_32x32x16_bf16 v[52:67], v[180:183], v[192:195], v[52:67]
    ds_read_b64_tr_b16 v[168:169], v31 offset:49152
    ds_read_b64_tr_b16 v[170:171], v31 offset:50176
    s_add_u32 m0, s43, 0x0
    s_nop 0
    buffer_load_dwordx4 v4, s[8:11], s41 offen lds
    v_mfma_f32_32x32x16_bf16 v[68:83], v[184:187], v[188:191], v[68:83]
    ds_read_b128 v[172:175], v16 offset:49152
    ds_read_b128 v[176:179], v16 offset:53248
    s_add_u32 m0, s43, 0x400
    s_nop 0
    buffer_load_dwordx4 v5, s[8:11], s41 offen lds
    v_mfma_f32_32x32x16_bf16 v[84:99], v[184:187], v[192:195], v[84:99]
    s_add_u32 m0, s43, 0x800
    s_nop 0
    buffer_load_dwordx4 v6, s[8:11], s41 offen lds
    s_waitcnt lgkmcnt(0)
    v_mfma_f32_32x32x16_bf16 v[36:51], v[164:167], v[172:175], v[36:51]
    ds_read_b64_tr_b16 v[180:181], v28 offset:53248
    ds_read_b64_tr_b16 v[182:183], v28 offset:54272
    v_mfma_f32_32x32x16_bf16 v[52:67], v[164:167], v[176:179], v[52:67]
    ds_read_b64_tr_b16 v[184:185], v31 offset:53248
    ds_read_b64_tr_b16 v[186:187], v31 offset:54272
    s_add_u32 m0, s43, 0xc00
    s_nop 0
    buffer_load_dwordx4 v7, s[8:11], s41 offen lds
    v_mfma_f32_32x32x16_bf16 v[68:83], v[168:171], v[172:175], v[68:83]
    ds_read_b128 v[188:191], v19 offset:49152
    ds_read_b128 v[192:195], v19 offset:53248
    s_add_u32 m0, s44, 0x0
    s_nop 0
    buffer_load_dwordx4 v8, s[12:15], s42 offen lds
    v_mfma_f32_32x32x16_bf16 v[84:99], v[168:171], v[176:179], v[84:99]
    s_add_u32 m0, s44, 0x400
    s_nop 0
    buffer_load_dwordx4 v9, s[12:15], s42 offen lds
    s_waitcnt lgkmcnt(0)
    v_mfma_f32_32x32x16_bf16 v[36:51], v[180:183], v[188:191], v[36:51]
    ds_read_b64_tr_b16 v[164:165], v28 offset:57344
    ds_read_b64_tr_b16 v[166:167], v28 offset:58368
    v_mfma_f32_32x32x16_bf16 v[52:67], v[180:183], v[192:195], v[52:67]
    ds_read_b64_tr_b16 v[168:169], v31 offset:57344
    ds_read_b64_tr_b16 v[170:171], v31 offset:58368
    s_add_u32 s41, s41, 128
    s_add_u32 s42, s42, 0x80000
    v_mfma_f32_32x32x16_bf16 v[68:83], v[184:187], v[188:191], v[68:83]
    ds_read_b128 v[172:175], v22 offset:49152
    ds_read_b128 v[176:179], v22 offset:53248
    s_mov_b32 s59, 0x0
    buffer_load_dword v215, v214, s[16:19], s59 offen
    v_mfma_f32_32x32x16_bf16 v[84:99], v[184:187], v[192:195], v[84:99]
    s_waitcnt lgkmcnt(0)
    v_mfma_f32_32x32x16_bf16 v[36:51], v[164:167], v[172:175], v[36:51]
    ds_read_b64_tr_b16 v[180:181], v28 offset:61440
    ds_read_b64_tr_b16 v[182:183], v28 offset:62464
    v_mfma_f32_32x32x16_bf16 v[52:67], v[164:167], v[176:179], v[52:67]
    ds_read_b64_tr_b16 v[184:185], v31 offset:61440
    ds_read_b64_tr_b16 v[186:187], v31 offset:62464
    v_mfma_f32_32x32x16_bf16 v[68:83], v[168:171], v[172:175], v[68:83]
    ds_read_b128 v[188:191], v25 offset:49152
    ds_read_b128 v[192:195], v25 offset:53248
    v_mfma_f32_32x32x16_bf16 v[84:99], v[168:171], v[176:179], v[84:99]
    s_waitcnt vmcnt(9) lgkmcnt(0)
    s_barrier
    v_mfma_f32_32x32x16_bf16 v[36:51], v[180:183], v[188:191], v[36:51]
    ds_read_b64_tr_b16 v[164:165], v29 offset:32768
    ds_read_b64_tr_b16 v[166:167], v29 offset:33792
    v_mfma_f32_32x32x16_bf16 v[52:67], v[180:183], v[192:195], v[52:67]
    ds_read_b64_tr_b16 v[168:169], v32 offset:32768
    ds_read_b64_tr_b16 v[170:171], v32 offset:33792
    s_add_u32 m0, s43, 0xc000
    s_nop 0
    buffer_load_dwordx4 v4, s[8:11], s41 offen lds
    v_mfma_f32_32x32x16_bf16 v[68:83], v[184:187], v[188:191], v[68:83]
    ds_read_b128 v[172:175], v17 offset:32768
    ds_read_b128 v[176:179], v17 offset:36864
    s_add_u32 m0, s43, 0xc400
    s_nop 0
    buffer_load_dwordx4 v5, s[8:11], s41 offen lds
    v_mfma_f32_32x32x16_bf16 v[84:99], v[184:187], v[192:195], v[84:99]
    s_add_u32 m0, s43, 0xc800
    s_nop 0
    buffer_load_dwordx4 v6, s[8:11], s41 offen lds
    s_waitcnt lgkmcnt(0)
    v_mfma_f32_32x32x16_bf16 v[36:51], v[164:167], v[172:175], v[36:51]
    ds_read_b64_tr_b16 v[180:181], v29 offset:36864
    ds_read_b64_tr_b16 v[182:183], v29 offset:37888
    v_mfma_f32_32x32x16_bf16 v[52:67], v[164:167], v[176:179], v[52:67]
    ds_read_b64_tr_b16 v[184:185], v32 offset:36864
    ds_read_b64_tr_b16 v[186:187], v32 offset:37888
    s_add_u32 m0, s43, 0xcc00
    s_nop 0
    buffer_load_dwordx4 v7, s[8:11], s41 offen lds
    v_mfma_f32_32x32x16_bf16 v[68:83], v[168:171], v[172:175], v[68:83]
    ds_read_b128 v[188:191], v20 offset:32768
    ds_read_b128 v[192:195], v20 offset:36864
    s_add_u32 m0, s44, 0xc000
    s_nop 0
    buffer_load_dwordx4 v8, s[12:15], s42 offen lds
    v_mfma_f32_32x32x16_bf16 v[84:99], v[168:171], v[176:179], v[84:99]
    s_add_u32 m0, s44, 0xc400
    s_nop 0
    buffer_load_dwordx4 v9, s[12:15], s42 offen lds
    s_waitcnt lgkmcnt(0)
    v_mfma_f32_32x32x16_bf16 v[36:51], v[180:183], v[188:191], v[36:51]
    ds_read_b64_tr_b16 v[164:165], v29 offset:40960
    ds_read_b64_tr_b16 v[166:167], v29 offset:41984
    v_mfma_f32_32x32x16_bf16 v[52:67], v[180:183], v[192:195], v[52:67]
    ds_read_b64_tr_b16 v[168:169], v32 offset:40960
    ds_read_b64_tr_b16 v[170:171], v32 offset:41984
    s_sub_u32 s41, s41, 896
    s_sub_u32 s42, s42, 3670016
    v_mfma_f32_32x32x16_bf16 v[68:83], v[184:187], v[188:191], v[68:83]
    ds_read_b128 v[172:175], v23 offset:32768
    ds_read_b128 v[176:179], v23 offset:36864
    s_mov_b32 s59, 0x80000
    buffer_load_dword v215, v214, s[16:19], s59 offen
    v_mfma_f32_32x32x16_bf16 v[84:99], v[184:187], v[192:195], v[84:99]
    s_waitcnt lgkmcnt(0)
    v_mfma_f32_32x32x16_bf16 v[36:51], v[164:167], v[172:175], v[36:51]
    ds_read_b64_tr_b16 v[180:181], v29 offset:45056
    ds_read_b64_tr_b16 v[182:183], v29 offset:46080
    v_mfma_f32_32x32x16_bf16 v[52:67], v[164:167], v[176:179], v[52:67]
    ds_read_b64_tr_b16 v[184:185], v32 offset:45056
    ds_read_b64_tr_b16 v[186:187], v32 offset:46080
    v_mfma_f32_32x32x16_bf16 v[68:83], v[168:171], v[172:175], v[68:83]
    ds_read_b128 v[188:191], v26 offset:32768
    ds_read_b128 v[192:195], v26 offset:36864
    v_mfma_f32_32x32x16_bf16 v[84:99], v[168:171], v[176:179], v[84:99]
    s_waitcnt vmcnt(8) lgkmcnt(0)
    s_barrier
    v_mfma_f32_32x32x16_bf16 v[36:51], v[180:183], v[188:191], v[36:51]
    ds_read_b64_tr_b16 v[164:165], v28 offset:0
    ds_read_b64_tr_b16 v[166:167], v28 offset:1024
    v_mfma_f32_32x32x16_bf16 v[52:67], v[180:183], v[192:195], v[52:67]
    ds_read_b64_tr_b16 v[168:169], v31 offset:0
    ds_read_b64_tr_b16 v[170:171], v31 offset:1024
    s_add_u32 m0, s43, 0x18000
    s_nop 0
    buffer_load_dwordx4 v4, s[8:11], s41 offen lds
    v_mfma_f32_32x32x16_bf16 v[68:83], v[184:187], v[188:191], v[68:83]
    ds_read_b128 v[172:175], v16 offset:0
    ds_read_b128 v[176:179], v16 offset:4096
    s_add_u32 m0, s43, 0x18400
    s_nop 0
    buffer_load_dwordx4 v5, s[8:11], s41 offen lds
    v_mfma_f32_32x32x16_bf16 v[84:99], v[184:187], v[192:195], v[84:99]
    s_add_u32 m0, s43, 0x18800
    s_nop 0
    buffer_load_dwordx4 v6, s[8:11], s41 offen lds
    s_waitcnt lgkmcnt(0)
    v_mfma_f32_32x32x16_bf16 v[36:51], v[164:167], v[172:175], v[36:51]
    ds_read_b64_tr_b16 v[180:181], v28 offset:4096
    ds_read_b64_tr_b16 v[182:183], v28 offset:5120
    v_mfma_f32_32x32x16_bf16 v[52:67], v[164:167], v[176:179], v[52:67]
    ds_read_b64_tr_b16 v[184:185], v31 offset:4096
    ds_read_b64_tr_b16 v[186:187], v31 offset:5120
    s_add_u32 m0, s43, 0x18c00
    s_nop 0
    buffer_load_dwordx4 v7, s[8:11], s41 offen lds
    v_mfma_f32_32x32x16_bf16 v[68:83], v[168:171], v[172:175], v[68:83]
    ds_read_b128 v[188:191], v19 offset:0
    ds_read_b128 v[192:195], v19 offset:4096
    s_add_u32 m0, s44, 0x18000
    s_nop 0
    buffer_load_dwordx4 v8, s[16:19], s42 offen lds
    v_mfma_f32_32x32x16_bf16 v[84:99], v[168:171], v[176:179], v[84:99]
    s_add_u32 m0, s44, 0x18400
    s_nop 0
    buffer_load_dwordx4 v9, s[16:19], s42 offen lds
    s_waitcnt lgkmcnt(0)
    v_mfma_f32_32x32x16_bf16 v[36:51], v[180:183], v[188:191], v[36:51]
    ds_read_b64_tr_b16 v[164:165], v28 offset:8192
    ds_read_b64_tr_b16 v[166:167], v28 offset:9216
    v_mfma_f32_32x32x16_bf16 v[52:67], v[180:183], v[192:195], v[52:67]
    ds_read_b64_tr_b16 v[168:169], v31 offset:8192
    ds_read_b64_tr_b16 v[170:171], v31 offset:9216
    s_add_u32 s41, s41, 128
    s_add_u32 s42, s42, 0x80000
    v_mfma_f32_32x32x16_bf16 v[68:83], v[184:187], v[188:191], v[68:83]
    ds_read_b128 v[172:175], v22 offset:0
    ds_read_b128 v[176:179], v22 offset:4096
    s_mov_b32 s59, 0x100000
    buffer_load_dword v215, v214, s[16:19], s59 offen
    v_mfma_f32_32x32x16_bf16 v[84:99], v[184:187], v[192:195], v[84:99]
    s_waitcnt lgkmcnt(0)
    v_mfma_f32_32x32x16_bf16 v[36:51], v[164:167], v[172:175], v[36:51]
    ds_read_b64_tr_b16 v[180:181], v28 offset:12288
    ds_read_b64_tr_b16 v[182:183], v28 offset:13312
    v_mfma_f32_32x32x16_bf16 v[52:67], v[164:167], v[176:179], v[52:67]
    ds_read_b64_tr_b16 v[184:185], v31 offset:12288
    ds_read_b64_tr_b16 v[186:187], v31 offset:13312
    v_mfma_f32_32x32x16_bf16 v[68:83], v[168:171], v[172:175], v[68:83]
    ds_read_b128 v[188:191], v25 offset:0
    ds_read_b128 v[192:195], v25 offset:4096
    v_mfma_f32_32x32x16_bf16 v[84:99], v[168:171], v[176:179], v[84:99]
    s_waitcnt vmcnt(8) lgkmcnt(0)
    s_barrier
    v_mfma_f32_32x32x16_bf16 v[36:51], v[180:183], v[188:191], v[36:51]
    ds_read_b64_tr_b16 v[164:165], v28 offset:49152
    ds_read_b64_tr_b16 v[166:167], v28 offset:50176
    v_mfma_f32_32x32x16_bf16 v[52:67], v[180:183], v[192:195], v[52:67]
    ds_read_b64_tr_b16 v[168:169], v31 offset:49152
    ds_read_b64_tr_b16 v[170:171], v31 offset:50176
    s_add_u32 m0, s43, 0x0
    s_nop 0
    buffer_load_dwordx4 v4, s[8:11], s41 offen lds
    v_mfma_f32_32x32x16_bf16 v[68:83], v[184:187], v[188:191], v[68:83]
    ds_read_b128 v[172:175], v16 offset:49152
    ds_read_b128 v[176:179], v16 offset:53248
    s_add_u32 m0, s43, 0x400
    s_nop 0
    buffer_load_dwordx4 v5, s[8:11], s41 offen lds
    v_mfma_f32_32x32x16_bf16 v[84:99], v[184:187], v[192:195], v[84:99]
    s_add_u32 m0, s43, 0x800
    s_nop 0
    buffer_load_dwordx4 v6, s[8:11], s41 offen lds
    s_waitcnt lgkmcnt(0)
    v_mfma_f32_32x32x16_bf16 v[36:51], v[164:167], v[172:175], v[36:51]
    ds_read_b64_tr_b16 v[180:181], v28 offset:53248
    ds_read_b64_tr_b16 v[182:183], v28 offset:54272
    v_mfma_f32_32x32x16_bf16 v[52:67], v[164:167], v[176:179], v[52:67]
    ds_read_b64_tr_b16 v[184:185], v31 offset:53248
    ds_read_b64_tr_b16 v[186:187], v31 offset:54272
    s_add_u32 m0, s43, 0xc00
    s_nop 0
    buffer_load_dwordx4 v7, s[8:11], s41 offen lds
    v_mfma_f32_32x32x16_bf16 v[68:83], v[168:171], v[172:175], v[68:83]
    ds_read_b128 v[188:191], v19 offset:49152
    ds_read_b128 v[192:195], v19 offset:53248
    s_add_u32 m0, s44, 0x0
    s_nop 0
    buffer_load_dwordx4 v8, s[16:19], s42 offen lds
    v_mfma_f32_32x32x16_bf16 v[84:99], v[168:171], v[176:179], v[84:99]
    s_add_u32 m0, s44, 0x400
    s_nop 0
    buffer_load_dwordx4 v9, s[16:19], s42 offen lds
    s_waitcnt lgkmcnt(0)
    v_mfma_f32_32x32x16_bf16 v[36:51], v[180:183], v[188:191], v[36:51]
    ds_read_b64_tr_b16 v[164:165], v28 offset:57344
    ds_read_b64_tr_b16 v[166:167], v28 offset:58368
    v_mfma_f32_32x32x16_bf16 v[52:67], v[180:183], v[192:195], v[52:67]
    ds_read_b64_tr_b16 v[168:169], v31 offset:57344
    ds_read_b64_tr_b16 v[170:171], v31 offset:58368
    s_add_u32 s41, s41, 128
    s_add_u32 s42, s42, 0x80000
    v_mfma_f32_32x32x16_bf16 v[68:83], v[184:187], v[188:191], v[68:83]
    ds_read_b128 v[172:175], v22 offset:49152
    ds_read_b128 v[176:179], v22 offset:53248
    s_mov_b32 s59, 0x180000
    buffer_load_dword v215, v214, s[16:19], s59 offen
    v_mfma_f32_32x32x16_bf16 v[84:99], v[184:187], v[192:195], v[84:99]
    s_waitcnt lgkmcnt(0)
    v_mfma_f32_32x32x16_bf16 v[36:51], v[164:167], v[172:175], v[36:51]
    ds_read_b64_tr_b16 v[180:181], v28 offset:61440
    ds_read_b64_tr_b16 v[182:183], v28 offset:62464
    v_mfma_f32_32x32x16_bf16 v[52:67], v[164:167], v[176:179], v[52:67]
    ds_read_b64_tr_b16 v[184:185], v31 offset:61440
    ds_read_b64_tr_b16 v[186:187], v31 offset:62464
    v_mfma_f32_32x32x16_bf16 v[68:83], v[168:171], v[172:175], v[68:83]
    ds_read_b128 v[188:191], v25 offset:49152
    ds_read_b128 v[192:195], v25 offset:53248
    v_mfma_f32_32x32x16_bf16 v[84:99], v[168:171], v[176:179], v[84:99]
    s_waitcnt vmcnt(8) lgkmcnt(0)
    s_barrier
    v_mfma_f32_32x32x16_bf16 v[36:51], v[180:183], v[188:191], v[36:51]
    ds_read_b64_tr_b16 v[164:165], v29 offset:32768
    ds_read_b64_tr_b16 v[166:167], v29 offset:33792
    v_mfma_f32_32x32x16_bf16 v[52:67], v[180:183], v[192:195], v[52:67]
    ds_read_b64_tr_b16 v[168:169], v32 offset:32768
    ds_read_b64_tr_b16 v[170:171], v32 offset:33792
    s_add_u32 m0, s43, 0xc000
    s_nop 0
    buffer_load_dwordx4 v4, s[8:11], s41 offen lds
    v_mfma_f32_32x32x16_bf16 v[68:83], v[184:187], v[188:191], v[68:83]
    ds_read_b128 v[172:175], v17 offset:32768
    ds_read_b128 v[176:179], v17 offset:36864
    s_add_u32 m0, s43, 0xc400
    s_nop 0
    buffer_load_dwordx4 v5, s[8:11], s41 offen lds
    v_mfma_f32_32x32x16_bf16 v[84:99], v[184:187], v[192:195], v[84:99]
    s_add_u32 m0, s43, 0xc800
    s_nop 0
    buffer_load_dwordx4 v6, s[8:11], s41 offen lds
    s_waitcnt lgkmcnt(0)
    v_mfma_f32_32x32x16_bf16 v[100:115], v[172:175], v[164:167], v[100:115]
    ds_read_b64_tr_b16 v[180:181], v29 offset:36864
    ds_read_b64_tr_b16 v[182:183], v29 offset:37888
    v_mfma_f32_32x32x16_bf16 v[116:131], v[176:179], v[164:167], v[116:131]
    ds_read_b64_tr_b16 v[184:185], v32 offset:36864
    ds_read_b64_tr_b16 v[186:187], v32 offset:37888
    s_add_u32 m0, s43, 0xcc00
    s_nop 0
    buffer_load_dwordx4 v7, s[8:11], s41 offen lds
    v_mfma_f32_32x32x16_bf16 v[132:147], v[172:175], v[168:171], v[132:147]
    ds_read_b128 v[188:191], v20 offset:32768
    ds_read_b128 v[192:195], v20 offset:36864
    s_add_u32 m0, s44, 0xc000
    s_nop 0
    buffer_load_dwordx4 v8, s[16:19], s42 offen lds
    v_mfma_f32_32x32x16_bf16 v[148:163], v[176:179], v[168:171], v[148:163]
    s_add_u32 m0, s44, 0xc400
    s_nop 0
    buffer_load_dwordx4 v9, s[16:19], s42 offen lds
    s_waitcnt lgkmcnt(0)
    v_mfma_f32_32x32x16_bf16 v[100:115], v[188:191], v[180:183], v[100:115]
    ds_read_b64_tr_b16 v[164:165], v29 offset:40960
    ds_read_b64_tr_b16 v[166:167], v29 offset:41984
    v_mfma_f32_32x32x16_bf16 v[116:131], v[192:195], v[180:183], v[116:131]
    ds_read_b64_tr_b16 v[168:169], v32 offset:40960
    ds_read_b64_tr_b16 v[170:171], v32 offset:41984
    s_add_u32 s41, s41, 128
    s_add_u32 s42, s42, 0x80000
    v_mfma_f32_32x32x16_bf16 v[132:147], v[188:191], v[184:187], v[132:147]
    ds_read_b128 v[172:175], v23 offset:32768
    ds_read_b128 v[176:179], v23 offset:36864
    s_mov_b32 s59, 0x200000
    buffer_load_dword v215, v214, s[16:19], s59 offen
    v_mfma_f32_32x32x16_bf16 v[148:163], v[192:195], v[184:187], v[148:163]
    v_cvt_pk_bf16_f32 v196, v36, v37
    v_cvt_pk_bf16_f32 v197, v38, v39
    s_waitcnt lgkmcnt(0)
    v_mfma_f32_32x32x16_bf16 v[100:115], v[172:175], v[164:167], v[100:115]
    ds_read_b64_tr_b16 v[180:181], v29 offset:45056
    ds_read_b64_tr_b16 v[182:183], v29 offset:46080
    v_mfma_f32_32x32x16_bf16 v[116:131], v[176:179], v[164:167], v[116:131]
    ds_read_b64_tr_b16 v[184:185], v32 offset:45056
    ds_read_b64_tr_b16 v[186:187], v32 offset:46080
    v_cvt_pk_bf16_f32 v198, v40, v41
    v_cvt_pk_bf16_f32 v199, v42, v43
    v_mfma_f32_32x32x16_bf16 v[132:147], v[172:175], v[168:171], v[132:147]
    ds_read_b128 v[188:191], v26 offset:32768
    ds_read_b128 v[192:195], v26 offset:36864
    s_add_u32 s47, s56, 0
    buffer_store_dwordx4 v[196:199], v212, s[20:23], s47 offen
    v_mfma_f32_32x32x16_bf16 v[148:163], v[176:179], v[168:171], v[148:163]
    s_waitcnt vmcnt(9) lgkmcnt(0)
    s_barrier
    v_mfma_f32_32x32x16_bf16 v[100:115], v[188:191], v[180:183], v[100:115]
    ds_read_b64_tr_b16 v[164:165], v28 offset:0
    ds_read_b64_tr_b16 v[166:167], v28 offset:1024
    v_mfma_f32_32x32x16_bf16 v[116:131], v[192:195], v[180:183], v[116:131]
    ds_read_b64_tr_b16 v[168:169], v31 offset:0
    ds_read_b64_tr_b16 v[170:171], v31 offset:1024
    s_add_u32 m0, s43, 0x18000
    s_nop 0
    buffer_load_dwordx4 v4, s[8:11], s41 offen lds
    v_mfma_f32_32x32x16_bf16 v[132:147], v[188:191], v[184:187], v[132:147]
    ds_read_b128 v[172:175], v16 offset:0
    ds_read_b128 v[176:179], v16 offset:4096
    s_add_u32 m0, s43, 0x18400
    s_nop 0
    buffer_load_dwordx4 v5, s[8:11], s41 offen lds
    v_mfma_f32_32x32x16_bf16 v[148:163], v[192:195], v[184:187], v[148:163]
    s_add_u32 m0, s43, 0x18800
    s_nop 0
    buffer_load_dwordx4 v6, s[8:11], s41 offen lds
    s_waitcnt lgkmcnt(0)
    v_mfma_f32_32x32x16_bf16 v[100:115], v[172:175], v[164:167], v[100:115]
    ds_read_b64_tr_b16 v[180:181], v28 offset:4096
    ds_read_b64_tr_b16 v[182:183], v28 offset:5120
    v_mfma_f32_32x32x16_bf16 v[116:131], v[176:179], v[164:167], v[116:131]
    ds_read_b64_tr_b16 v[184:185], v31 offset:4096
    ds_read_b64_tr_b16 v[186:187], v31 offset:5120
    s_add_u32 m0, s43, 0x18c00
    s_nop 0
    buffer_load_dwordx4 v7, s[8:11], s41 offen lds
    v_mfma_f32_32x32x16_bf16 v[132:147], v[172:175], v[168:171], v[132:147]
    ds_read_b128 v[188:191], v19 offset:0
    ds_read_b128 v[192:195], v19 offset:4096
    s_add_u32 m0, s44, 0x18000
    s_nop 0
    buffer_load_dwordx4 v8, s[16:19], s42 offen lds
    v_mfma_f32_32x32x16_bf16 v[148:163], v[176:179], v[168:171], v[148:163]
    s_add_u32 m0, s44, 0x18400
    s_nop 0
    buffer_load_dwordx4 v9, s[16:19], s42 offen lds
    s_waitcnt lgkmcnt(0)
    v_mfma_f32_32x32x16_bf16 v[100:115], v[188:191], v[180:183], v[100:115]
    ds_read_b64_tr_b16 v[164:165], v28 offset:8192
    ds_read_b64_tr_b16 v[166:167], v28 offset:9216
    v_mfma_f32_32x32x16_bf16 v[116:131], v[192:195], v[180:183], v[116:131]
    ds_read_b64_tr_b16 v[168:169], v31 offset:8192
    ds_read_b64_tr_b16 v[170:171], v31 offset:9216
    s_add_u32 s41, s41, 128
    s_add_u32 s42, s42, 0x80000
    v_mfma_f32_32x32x16_bf16 v[132:147], v[188:191], v[184:187], v[132:147]
    ds_read_b128 v[172:175], v22 offset:0
    ds_read_b128 v[176:179], v22 offset:4096
    s_mov_b32 s59, 0x280000
    buffer_load_dword v215, v214, s[16:19], s59 offen
    v_mfma_f32_32x32x16_bf16 v[148:163], v[192:195], v[184:187], v[148:163]
    v_cvt_pk_bf16_f32 v200, v44, v45
    v_cvt_pk_bf16_f32 v201, v46, v47
    s_waitcnt lgkmcnt(0)
    v_mfma_f32_32x32x16_bf16 v[100:115], v[172:175], v[164:167], v[100:115]
    ds_read_b64_tr_b16 v[180:181], v28 offset:12288
    ds_read_b64_tr_b16 v[182:183], v28 offset:13312
    v_mfma_f32_32x32x16_bf16 v[116:131], v[176:179], v[164:167], v[116:131]
    ds_read_b64_tr_b16 v[184:185], v31 offset:12288
    ds_read_b64_tr_b16 v[186:187], v31 offset:13312
    v_cvt_pk_bf16_f32 v202, v48, v49
    v_cvt_pk_bf16_f32 v203, v50, v51
    v_mfma_f32_32x32x16_bf16 v[132:147], v[172:175], v[168:171], v[132:147]
    ds_read_b128 v[188:191], v25 offset:0
    ds_read_b128 v[192:195], v25 offset:4096
    s_add_u32 s47, s56, 1024
    buffer_store_dwordx4 v[200:203], v212, s[20:23], s47 offen
    v_mfma_f32_32x32x16_bf16 v[148:163], v[176:179], v[168:171], v[148:163]
    s_waitcnt vmcnt(10) lgkmcnt(0)
    s_barrier
    v_mfma_f32_32x32x16_bf16 v[100:115], v[188:191], v[180:183], v[100:115]
    ds_read_b64_tr_b16 v[164:165], v28 offset:49152
    ds_read_b64_tr_b16 v[166:167], v28 offset:50176
    v_mfma_f32_32x32x16_bf16 v[116:131], v[192:195], v[180:183], v[116:131]
    ds_read_b64_tr_b16 v[168:169], v31 offset:49152
    ds_read_b64_tr_b16 v[170:171], v31 offset:50176
    s_add_u32 m0, s43, 0x0
    s_nop 0
    buffer_load_dwordx4 v4, s[8:11], s41 offen lds
    v_mfma_f32_32x32x16_bf16 v[132:147], v[188:191], v[184:187], v[132:147]
    ds_read_b128 v[172:175], v16 offset:49152
    ds_read_b128 v[176:179], v16 offset:53248
    s_add_u32 m0, s43, 0x400
    s_nop 0
    buffer_load_dwordx4 v5, s[8:11], s41 offen lds
    v_mfma_f32_32x32x16_bf16 v[148:163], v[192:195], v[184:187], v[148:163]
    s_add_u32 m0, s43, 0x800
    s_nop 0
    buffer_load_dwordx4 v6, s[8:11], s41 offen lds
    s_waitcnt lgkmcnt(0)
    v_mfma_f32_32x32x16_bf16 v[100:115], v[172:175], v[164:167], v[100:115]
    ds_read_b64_tr_b16 v[180:181], v28 offset:53248
    ds_read_b64_tr_b16 v[182:183], v28 offset:54272
    v_mfma_f32_32x32x16_bf16 v[116:131], v[176:179], v[164:167], v[116:131]
    ds_read_b64_tr_b16 v[184:185], v31 offset:53248
    ds_read_b64_tr_b16 v[186:187], v31 offset:54272
    s_add_u32 m0, s43, 0xc00
    s_nop 0
    buffer_load_dwordx4 v7, s[8:11], s41 offen lds
    v_mfma_f32_32x32x16_bf16 v[132:147], v[172:175], v[168:171], v[132:147]
    ds_read_b128 v[188:191], v19 offset:49152
    ds_read_b128 v[192:195], v19 offset:53248
    s_add_u32 m0, s44, 0x0
    s_nop 0
    buffer_load_dwordx4 v8, s[16:19], s42 offen lds
    v_mfma_f32_32x32x16_bf16 v[148:163], v[176:179], v[168:171], v[148:163]
    s_add_u32 m0, s44, 0x400
    s_nop 0
    buffer_load_dwordx4 v9, s[16:19], s42 offen lds
    s_waitcnt lgkmcnt(0)
    v_mfma_f32_32x32x16_bf16 v[100:115], v[188:191], v[180:183], v[100:115]
    ds_read_b64_tr_b16 v[164:165], v28 offset:57344
    ds_read_b64_tr_b16 v[166:167], v28 offset:58368
    v_mfma_f32_32x32x16_bf16 v[116:131], v[192:195], v[180:183], v[116:131]
    ds_read_b64_tr_b16 v[168:169], v31 offset:57344
    ds_read_b64_tr_b16 v[170:171], v31 offset:58368
    s_add_u32 s41, s41, 128
    s_add_u32 s42, s42, 0x80000
    v_mfma_f32_32x32x16_bf16 v[132:147], v[188:191], v[184:187], v[132:147]
    ds_read_b128 v[172:175], v22 offset:49152
    ds_read_b128 v[176:179], v22 offset:53248
    s_mov_b32 s59, 0x300000
    buffer_load_dword v215, v214, s[16:19], s59 offen
    v_mfma_f32_32x32x16_bf16 v[148:163], v[192:195], v[184:187], v[148:163]
    v_cvt_pk_bf16_f32 v204, v52, v53
    v_cvt_pk_bf16_f32 v205, v54, v55
    s_waitcnt lgkmcnt(0)
    v_mfma_f32_32x32x16_bf16 v[100:115], v[172:175], v[164:167], v[100:115]
    ds_read_b64_tr_b16 v[180:181], v28 offset:61440
    ds_read_b64_tr_b16 v[182:183], v28 offset:62464
    v_mfma_f32_32x32x16_bf16 v[116:131], v[176:179], v[164:167], v[116:131]
    ds_read_b64_tr_b16 v[184:185], v31 offset:61440
    ds_read_b64_tr_b16 v[186:187], v31 offset:62464
    v_cvt_pk_bf16_f32 v206, v56, v57
    v_cvt_pk_bf16_f32 v207, v58, v59
    v_mfma_f32_32x32x16_bf16 v[132:147], v[172:175], v[168:171], v[132:147]
    ds_read_b128 v[188:191], v25 offset:49152
    ds_read_b128 v[192:195], v25 offset:53248
    s_add_u32 s47, s56, 8192
    buffer_store_dwordx4 v[204:207], v212, s[20:23], s47 offen
    v_mfma_f32_32x32x16_bf16 v[148:163], v[176:179], v[168:171], v[148:163]
    s_waitcnt vmcnt(10) lgkmcnt(0)
    s_barrier
    v_mfma_f32_32x32x16_bf16 v[100:115], v[188:191], v[180:183], v[100:115]
    ds_read_b64_tr_b16 v[164:165], v29 offset:32768
    ds_read_b64_tr_b16 v[166:167], v29 offset:33792
    v_mfma_f32_32x32x16_bf16 v[116:131], v[192:195], v[180:183], v[116:131]
    ds_read_b64_tr_b16 v[168:169], v32 offset:32768
    ds_read_b64_tr_b16 v[170:171], v32 offset:33792
    s_add_u32 m0, s43, 0xc000
    s_nop 0
    buffer_load_dwordx4 v4, s[8:11], s41 offen lds
    v_mfma_f32_32x32x16_bf16 v[132:147], v[188:191], v[184:187], v[132:147]
    ds_read_b128 v[172:175], v17 offset:32768
    ds_read_b128 v[176:179], v17 offset:36864
    s_add_u32 m0, s43, 0xc400
    s_nop 0
    buffer_load_dwordx4 v5, s[8:11], s41 offen lds
    v_mfma_f32_32x32x16_bf16 v[148:163], v[192:195], v[184:187], v[148:163]
    s_add_u32 m0, s43, 0xc800
    s_nop 0
    buffer_load_dwordx4 v6, s[8:11], s41 offen lds
    s_waitcnt lgkmcnt(0)
    v_mfma_f32_32x32x16_bf16 v[100:115], v[172:175], v[164:167], v[100:115]
    ds_read_b64_tr_b16 v[180:181], v29 offset:36864
    ds_read_b64_tr_b16 v[182:183], v29 offset:37888
    v_mfma_f32_32x32x16_bf16 v[116:131], v[176:179], v[164:167], v[116:131]
    ds_read_b64_tr_b16 v[184:185], v32 offset:36864
    ds_read_b64_tr_b16 v[186:187], v32 offset:37888
    s_add_u32 m0, s43, 0xcc00
    s_nop 0
    buffer_load_dwordx4 v7, s[8:11], s41 offen lds
    v_mfma_f32_32x32x16_bf16 v[132:147], v[172:175], v[168:171], v[132:147]
    ds_read_b128 v[188:191], v20 offset:32768
    ds_read_b128 v[192:195], v20 offset:36864
    s_add_u32 m0, s44, 0xc000
    s_nop 0
    buffer_load_dwordx4 v8, s[16:19], s42 offen lds
    v_mfma_f32_32x32x16_bf16 v[148:163], v[176:179], v[168:171], v[148:163]
    s_add_u32 m0, s44, 0xc400
    s_nop 0
    buffer_load_dwordx4 v9, s[16:19], s42 offen lds
    s_waitcnt lgkmcnt(0)
    v_mfma_f32_32x32x16_bf16 v[100:115], v[188:191], v[180:183], v[100:115]
    ds_read_b64_tr_b16 v[164:165], v29 offset:40960
    ds_read_b64_tr_b16 v[166:167], v29 offset:41984
    v_mfma_f32_32x32x16_bf16 v[116:131], v[192:195], v[180:183], v[116:131]
    ds_read_b64_tr_b16 v[168:169], v32 offset:40960
    ds_read_b64_tr_b16 v[170:171], v32 offset:41984
    s_add_u32 s41, s41, 128
    s_add_u32 s42, s42, 0x80000
    v_mfma_f32_32x32x16_bf16 v[132:147], v[188:191], v[184:187], v[132:147]
    ds_read_b128 v[172:175], v23 offset:32768
    ds_read_b128 v[176:179], v23 offset:36864
    s_mov_b32 s59, 0x380000
    buffer_load_dword v215, v214, s[16:19], s59 offen
    v_mfma_f32_32x32x16_bf16 v[148:163], v[192:195], v[184:187], v[148:163]
    v_cvt_pk_bf16_f32 v208, v60, v61
    v_cvt_pk_bf16_f32 v209, v62, v63
    s_waitcnt lgkmcnt(0)
    v_mfma_f32_32x32x16_bf16 v[100:115], v[172:175], v[164:167], v[100:115]
    ds_read_b64_tr_b16 v[180:181], v29 offset:45056
    ds_read_b64_tr_b16 v[182:183], v29 offset:46080
    v_mfma_f32_32x32x16_bf16 v[116:131], v[176:179], v[164:167], v[116:131]
    ds_read_b64_tr_b16 v[184:185], v32 offset:45056
    ds_read_b64_tr_b16 v[186:187], v32 offset:46080
    v_cvt_pk_bf16_f32 v210, v64, v65
    v_cvt_pk_bf16_f32 v211, v66, v67
    v_mfma_f32_32x32x16_bf16 v[132:147], v[172:175], v[168:171], v[132:147]
    ds_read_b128 v[188:191], v26 offset:32768
    ds_read_b128 v[192:195], v26 offset:36864
    s_add_u32 s47, s56, 9216
    buffer_store_dwordx4 v[208:211], v212, s[20:23], s47 offen
    v_mfma_f32_32x32x16_bf16 v[148:163], v[176:179], v[168:171], v[148:163]
    s_waitcnt vmcnt(10) lgkmcnt(0)
    s_barrier
    v_mfma_f32_32x32x16_bf16 v[100:115], v[188:191], v[180:183], v[100:115]
    ds_read_b64_tr_b16 v[164:165], v28 offset:0
    ds_read_b64_tr_b16 v[166:167], v28 offset:1024
    v_mfma_f32_32x32x16_bf16 v[116:131], v[192:195], v[180:183], v[116:131]
    ds_read_b64_tr_b16 v[168:169], v31 offset:0
    ds_read_b64_tr_b16 v[170:171], v31 offset:1024
    s_add_u32 m0, s43, 0x18000
    s_nop 0
    buffer_load_dwordx4 v4, s[8:11], s41 offen lds
    v_mfma_f32_32x32x16_bf16 v[132:147], v[188:191], v[184:187], v[132:147]
    ds_read_b128 v[172:175], v16 offset:0
    ds_read_b128 v[176:179], v16 offset:4096
    s_add_u32 m0, s43, 0x18400
    s_nop 0
    buffer_load_dwordx4 v5, s[8:11], s41 offen lds
    v_mfma_f32_32x32x16_bf16 v[148:163], v[192:195], v[184:187], v[148:163]
    s_add_u32 m0, s43, 0x18800
    s_nop 0
    buffer_load_dwordx4 v6, s[8:11], s41 offen lds
    s_waitcnt lgkmcnt(0)
    v_mfma_f32_32x32x16_bf16 v[100:115], v[172:175], v[164:167], v[100:115]
    ds_read_b64_tr_b16 v[180:181], v28 offset:4096
    ds_read_b64_tr_b16 v[182:183], v28 offset:5120
    v_mfma_f32_32x32x16_bf16 v[116:131], v[176:179], v[164:167], v[116:131]
    ds_read_b64_tr_b16 v[184:185], v31 offset:4096
    ds_read_b64_tr_b16 v[186:187], v31 offset:5120
    s_add_u32 m0, s43, 0x18c00
    s_nop 0
    buffer_load_dwordx4 v7, s[8:11], s41 offen lds
    v_mfma_f32_32x32x16_bf16 v[132:147], v[172:175], v[168:171], v[132:147]
    ds_read_b128 v[188:191], v19 offset:0
    ds_read_b128 v[192:195], v19 offset:4096
    s_add_u32 m0, s44, 0x18000
    s_nop 0
    buffer_load_dwordx4 v8, s[16:19], s42 offen lds
    v_mfma_f32_32x32x16_bf16 v[148:163], v[176:179], v[168:171], v[148:163]
    s_add_u32 m0, s44, 0x18400
    s_nop 0
    buffer_load_dwordx4 v9, s[16:19], s42 offen lds
    s_waitcnt lgkmcnt(0)
    v_mfma_f32_32x32x16_bf16 v[100:115], v[188:191], v[180:183], v[100:115]
    ds_read_b64_tr_b16 v[164:165], v28 offset:8192
    ds_read_b64_tr_b16 v[166:167], v28 offset:9216
    v_mfma_f32_32x32x16_bf16 v[116:131], v[192:195], v[180:183], v[116:131]
    ds_read_b64_tr_b16 v[168:169], v31 offset:8192
    ds_read_b64_tr_b16 v[170:171], v31 offset:9216
    s_add_u32 s41, s41, 128
    s_add_u32 s42, s42, 0x80000
    v_mfma_f32_32x32x16_bf16 v[132:147], v[188:191], v[184:187], v[132:147]
    ds_read_b128 v[172:175], v22 offset:0
    ds_read_b128 v[176:179], v22 offset:4096
    v_cvt_pk_bf16_f32 v196, v68, v69
    v_cvt_pk_bf16_f32 v197, v70, v71
    v_mfma_f32_32x32x16_bf16 v[148:163], v[192:195], v[184:187], v[148:163]
    v_cvt_pk_bf16_f32 v198, v72, v73
    v_cvt_pk_bf16_f32 v199, v74, v75
    s_waitcnt lgkmcnt(0)
    v_mfma_f32_32x32x16_bf16 v[100:115], v[172:175], v[164:167], v[100:115]
    ds_read_b64_tr_b16 v[180:181], v28 offset:12288
    ds_read_b64_tr_b16 v[182:183], v28 offset:13312
    v_mfma_f32_32x32x16_bf16 v[116:131], v[176:179], v[164:167], v[116:131]
    ds_read_b64_tr_b16 v[184:185], v31 offset:12288
    ds_read_b64_tr_b16 v[186:187], v31 offset:13312
    s_add_u32 s47, s56, 2048
    buffer_store_dwordx4 v[196:199], v212, s[20:23], s47 offen
    v_mfma_f32_32x32x16_bf16 v[132:147], v[172:175], v[168:171], v[132:147]
    ds_read_b128 v[188:191], v25 offset:0
    ds_read_b128 v[192:195], v25 offset:4096
    v_mfma_f32_32x32x16_bf16 v[148:163], v[176:179], v[168:171], v[148:163]
    s_waitcnt vmcnt(9) lgkmcnt(0)
    s_barrier
    v_mfma_f32_32x32x16_bf16 v[100:115], v[188:191], v[180:183], v[100:115]
    ds_read_b64_tr_b16 v[164:165], v28 offset:49152
    ds_read_b64_tr_b16 v[166:167], v28 offset:50176
    v_mfma_f32_32x32x16_bf16 v[116:131], v[192:195], v[180:183], v[116:131]
    ds_read_b64_tr_b16 v[168:169], v31 offset:49152
    ds_read_b64_tr_b16 v[170:171], v31 offset:50176
    s_add_u32 m0, s43, 0x0
    s_nop 0
    buffer_load_dwordx4 v4, s[8:11], s41 offen lds
    v_mfma_f32_32x32x16_bf16 v[132:147], v[188:191], v[184:187], v[132:147]
    ds_read_b128 v[172:175], v16 offset:49152
    ds_read_b128 v[176:179], v16 offset:53248
    s_add_u32 m0, s43, 0x400
    s_nop 0
    buffer_load_dwordx4 v5, s[8:11], s41 offen lds
    v_mfma_f32_32x32x16_bf16 v[148:163], v[192:195], v[184:187], v[148:163]
    s_add_u32 m0, s43, 0x800
    s_nop 0
    buffer_load_dwordx4 v6, s[8:11], s41 offen lds
    s_waitcnt lgkmcnt(0)
    v_mfma_f32_32x32x16_bf16 v[100:115], v[172:175], v[164:167], v[100:115]
    ds_read_b64_tr_b16 v[180:181], v28 offset:53248
    ds_read_b64_tr_b16 v[182:183], v28 offset:54272
    v_mfma_f32_32x32x16_bf16 v[116:131], v[176:179], v[164:167], v[116:131]
    ds_read_b64_tr_b16 v[184:185], v31 offset:53248
    ds_read_b64_tr_b16 v[186:187], v31 offset:54272
    s_add_u32 m0, s43, 0xc00
    s_nop 0
    buffer_load_dwordx4 v7, s[8:11], s41 offen lds
    v_mfma_f32_32x32x16_bf16 v[132:147], v[172:175], v[168:171], v[132:147]
    ds_read_b128 v[188:191], v19 offset:49152
    ds_read_b128 v[192:195], v19 offset:53248
    s_add_u32 m0, s44, 0x0
    s_nop 0
    buffer_load_dwordx4 v8, s[16:19], s42 offen lds
    v_mfma_f32_32x32x16_bf16 v[148:163], v[176:179], v[168:171], v[148:163]
    s_add_u32 m0, s44, 0x400
    s_nop 0
    buffer_load_dwordx4 v9, s[16:19], s42 offen lds
    s_waitcnt lgkmcnt(0)
    v_mfma_f32_32x32x16_bf16 v[100:115], v[188:191], v[180:183], v[100:115]
    ds_read_b64_tr_b16 v[164:165], v28 offset:57344
    ds_read_b64_tr_b16 v[166:167], v28 offset:58368
    v_mfma_f32_32x32x16_bf16 v[116:131], v[192:195], v[180:183], v[116:131]
    ds_read_b64_tr_b16 v[168:169], v31 offset:57344
    ds_read_b64_tr_b16 v[170:171], v31 offset:58368
    s_add_u32 s41, s41, 128
    s_add_u32 s42, s42, 0x80000
    v_mfma_f32_32x32x16_bf16 v[132:147], v[188:191], v[184:187], v[132:147]
    ds_read_b128 v[172:175], v22 offset:49152
    ds_read_b128 v[176:179], v22 offset:53248
    v_cvt_pk_bf16_f32 v200, v76, v77
    v_cvt_pk_bf16_f32 v201, v78, v79
    v_mfma_f32_32x32x16_bf16 v[148:163], v[192:195], v[184:187], v[148:163]
    v_cvt_pk_bf16_f32 v202, v80, v81
    v_cvt_pk_bf16_f32 v203, v82, v83
    s_waitcnt lgkmcnt(0)
    v_mfma_f32_32x32x16_bf16 v[100:115], v[172:175], v[164:167], v[100:115]
    ds_read_b64_tr_b16 v[180:181], v28 offset:61440
    ds_read_b64_tr_b16 v[182:183], v28 offset:62464
    v_mfma_f32_32x32x16_bf16 v[116:131], v[176:179], v[164:167], v[116:131]
    ds_read_b64_tr_b16 v[184:185], v31 offset:61440
    ds_read_b64_tr_b16 v[186:187], v31 offset:62464
    s_add_u32 s47, s56, 3072
    buffer_store_dwordx4 v[200:203], v212, s[20:23], s47 offen
    v_mfma_f32_32x32x16_bf16 v[132:147], v[172:175], v[168:171], v[132:147]
    ds_read_b128 v[188:191], v25 offset:49152
    ds_read_b128 v[192:195], v25 offset:53248
    v_mfma_f32_32x32x16_bf16 v[148:163], v[176:179], v[168:171], v[148:163]
    s_waitcnt vmcnt(8) lgkmcnt(0)
    s_barrier
    v_mfma_f32_32x32x16_bf16 v[100:115], v[188:191], v[180:183], v[100:115]
    ds_read_b64_tr_b16 v[164:165], v29 offset:32768
    ds_read_b64_tr_b16 v[166:167], v29 offset:33792
    v_mfma_f32_32x32x16_bf16 v[116:131], v[192:195], v[180:183], v[116:131]
    ds_read_b64_tr_b16 v[168:169], v32 offset:32768
    ds_read_b64_tr_b16 v[170:171], v32 offset:33792
    v_mfma_f32_32x32x16_bf16 v[132:147], v[188:191], v[184:187], v[132:147]
    ds_read_b128 v[172:175], v17 offset:32768
    ds_read_b128 v[176:179], v17 offset:36864
    v_mfma_f32_32x32x16_bf16 v[148:163], v[192:195], v[184:187], v[148:163]
    s_waitcnt lgkmcnt(0)
    v_mfma_f32_32x32x16_bf16 v[100:115], v[172:175], v[164:167], v[100:115]
    ds_read_b64_tr_b16 v[180:181], v29 offset:36864
    ds_read_b64_tr_b16 v[182:183], v29 offset:37888
    v_mfma_f32_32x32x16_bf16 v[116:131], v[176:179], v[164:167], v[116:131]
    ds_read_b64_tr_b16 v[184:185], v32 offset:36864
    ds_read_b64_tr_b16 v[186:187], v32 offset:37888
    v_mfma_f32_32x32x16_bf16 v[132:147], v[172:175], v[168:171], v[132:147]
    ds_read_b128 v[188:191], v20 offset:32768
    ds_read_b128 v[192:195], v20 offset:36864
    v_mfma_f32_32x32x16_bf16 v[148:163], v[176:179], v[168:171], v[148:163]
    s_waitcnt lgkmcnt(0)
    v_mfma_f32_32x32x16_bf16 v[100:115], v[188:191], v[180:183], v[100:115]
    ds_read_b64_tr_b16 v[164:165], v29 offset:40960
    ds_read_b64_tr_b16 v[166:167], v29 offset:41984
    v_mfma_f32_32x32x16_bf16 v[116:131], v[192:195], v[180:183], v[116:131]
    ds_read_b64_tr_b16 v[168:169], v32 offset:40960
    ds_read_b64_tr_b16 v[170:171], v32 offset:41984
    v_cvt_pk_bf16_f32 v204, v84, v85
    v_cvt_pk_bf16_f32 v205, v86, v87
    v_mfma_f32_32x32x16_bf16 v[132:147], v[188:191], v[184:187], v[132:147]
    ds_read_b128 v[172:175], v23 offset:32768
    ds_read_b128 v[176:179], v23 offset:36864
    v_cvt_pk_bf16_f32 v206, v88, v89
    v_cvt_pk_bf16_f32 v207, v90, v91
    v_mfma_f32_32x32x16_bf16 v[148:163], v[192:195], v[184:187], v[148:163]
    s_add_u32 s47, s56, 10240
    buffer_store_dwordx4 v[204:207], v212, s[20:23], s47 offen
    s_waitcnt lgkmcnt(0)
    v_mfma_f32_32x32x16_bf16 v[100:115], v[172:175], v[164:167], v[100:115]
    ds_read_b64_tr_b16 v[180:181], v29 offset:45056
    ds_read_b64_tr_b16 v[182:183], v29 offset:46080
    v_mfma_f32_32x32x16_bf16 v[116:131], v[176:179], v[164:167], v[116:131]
    ds_read_b64_tr_b16 v[184:185], v32 offset:45056
    ds_read_b64_tr_b16 v[186:187], v32 offset:46080
    v_mfma_f32_32x32x16_bf16 v[132:147], v[172:175], v[168:171], v[132:147]
    ds_read_b128 v[188:191], v26 offset:32768
    ds_read_b128 v[192:195], v26 offset:36864
    v_mfma_f32_32x32x16_bf16 v[148:163], v[176:179], v[168:171], v[148:163]
    s_waitcnt vmcnt(2) lgkmcnt(0)
    s_barrier
    v_mfma_f32_32x32x16_bf16 v[100:115], v[188:191], v[180:183], v[100:115]
    ds_read_b64_tr_b16 v[164:165], v28 offset:0
    ds_read_b64_tr_b16 v[166:167], v28 offset:1024
    v_mfma_f32_32x32x16_bf16 v[116:131], v[192:195], v[180:183], v[116:131]
    ds_read_b64_tr_b16 v[168:169], v31 offset:0
    ds_read_b64_tr_b16 v[170:171], v31 offset:1024
    v_mfma_f32_32x32x16_bf16 v[132:147], v[188:191], v[184:187], v[132:147]
    ds_read_b128 v[172:175], v16 offset:0
    ds_read_b128 v[176:179], v16 offset:4096
    v_mfma_f32_32x32x16_bf16 v[148:163], v[192:195], v[184:187], v[148:163]
    s_waitcnt lgkmcnt(0)
    v_mfma_f32_32x32x16_bf16 v[100:115], v[172:175], v[164:167], v[100:115]
    ds_read_b64_tr_b16 v[180:181], v28 offset:4096
    ds_read_b64_tr_b16 v[182:183], v28 offset:5120
    v_mfma_f32_32x32x16_bf16 v[116:131], v[176:179], v[164:167], v[116:131]
    ds_read_b64_tr_b16 v[184:185], v31 offset:4096
    ds_read_b64_tr_b16 v[186:187], v31 offset:5120
    v_mfma_f32_32x32x16_bf16 v[132:147], v[172:175], v[168:171], v[132:147]
    ds_read_b128 v[188:191], v19 offset:0
    ds_read_b128 v[192:195], v19 offset:4096
    v_mfma_f32_32x32x16_bf16 v[148:163], v[176:179], v[168:171], v[148:163]
    s_waitcnt lgkmcnt(0)
    v_mfma_f32_32x32x16_bf16 v[100:115], v[188:191], v[180:183], v[100:115]
    ds_read_b64_tr_b16 v[164:165], v28 offset:8192
    ds_read_b64_tr_b16 v[166:167], v28 offset:9216
    v_mfma_f32_32x32x16_bf16 v[116:131], v[192:195], v[180:183], v[116:131]
    ds_read_b64_tr_b16 v[168:169], v31 offset:8192
    ds_read_b64_tr_b16 v[170:171], v31 offset:9216
    v_cvt_pk_bf16_f32 v208, v92, v93
    v_cvt_pk_bf16_f32 v209, v94, v95
    v_mfma_f32_32x32x16_bf16 v[132:147], v[188:191], v[184:187], v[132:147]
    ds_read_b128 v[172:175], v22 offset:0
    ds_read_b128 v[176:179], v22 offset:4096
    v_cvt_pk_bf16_f32 v210, v96, v97
    v_cvt_pk_bf16_f32 v211, v98, v99
    v_mfma_f32_32x32x16_bf16 v[148:163], v[192:195], v[184:187], v[148:163]
    s_add_u32 s47, s56, 11264
    buffer_store_dwordx4 v[208:211], v212, s[20:23], s47 offen
    s_waitcnt lgkmcnt(0)
    v_mfma_f32_32x32x16_bf16 v[100:115], v[172:175], v[164:167], v[100:115]
    ds_read_b64_tr_b16 v[180:181], v28 offset:12288
    ds_read_b64_tr_b16 v[182:183], v28 offset:13312
    v_mfma_f32_32x32x16_bf16 v[116:131], v[176:179], v[164:167], v[116:131]
    ds_read_b64_tr_b16 v[184:185], v31 offset:12288
    ds_read_b64_tr_b16 v[186:187], v31 offset:13312
    buffer_load_dword v215, v216, s[48:51], 0 offen
    v_mfma_f32_32x32x16_bf16 v[132:147], v[172:175], v[168:171], v[132:147]
    ds_read_b128 v[188:191], v25 offset:0
    ds_read_b128 v[192:195], v25 offset:4096
    v_mfma_f32_32x32x16_bf16 v[148:163], v[176:179], v[168:171], v[148:163]
    s_waitcnt lgkmcnt(0)
    v_mfma_f32_32x32x16_bf16 v[100:115], v[188:191], v[180:183], v[100:115]
    v_mfma_f32_32x32x16_bf16 v[116:131], v[192:195], v[180:183], v[116:131]
    v_mfma_f32_32x32x16_bf16 v[132:147], v[188:191], v[184:187], v[132:147]
    v_mfma_f32_32x32x16_bf16 v[148:163], v[192:195], v[184:187], v[148:163]
    s_nop 11
    v_cvt_pk_bf16_f32 v196, v100, v101
    v_cvt_pk_bf16_f32 v197, v102, v103
    v_cvt_pk_bf16_f32 v198, v104, v105
    v_cvt_pk_bf16_f32 v199, v106, v107
    s_add_u32 s47, s57, 0
    buffer_store_dwordx4 v[196:199], v212, s[24:27], s47 offen
    v_cvt_pk_bf16_f32 v200, v108, v109
    v_cvt_pk_bf16_f32 v201, v110, v111
    v_cvt_pk_bf16_f32 v202, v112, v113
    v_cvt_pk_bf16_f32 v203, v114, v115
    s_add_u32 s47, s57, 4096
    buffer_store_dwordx4 v[200:203], v212, s[24:27], s47 offen
    v_cvt_pk_bf16_f32 v204, v116, v117
    v_cvt_pk_bf16_f32 v205, v118, v119
    v_cvt_pk_bf16_f32 v206, v120, v121
    v_cvt_pk_bf16_f32 v207, v122, v123
    s_add_u32 s47, s57, 8192
    buffer_store_dwordx4 v[204:207], v212, s[24:27], s47 offen
    v_cvt_pk_bf16_f32 v208, v124, v125
    v_cvt_pk_bf16_f32 v209, v126, v127
    v_cvt_pk_bf16_f32 v210, v128, v129
    v_cvt_pk_bf16_f32 v211, v130, v131
    s_add_u32 s47, s57, 12288
    buffer_store_dwordx4 v[208:211], v212, s[24:27], s47 offen
    v_cvt_pk_bf16_f32 v196, v132, v133
    v_cvt_pk_bf16_f32 v197, v134, v135
    v_cvt_pk_bf16_f32 v198, v136, v137
    v_cvt_pk_bf16_f32 v199, v138, v139
    s_add_u32 s47, s57, 1024
    buffer_store_dwordx4 v[196:199], v212, s[24:27], s47 offen
    v_cvt_pk_bf16_f32 v200, v140, v141
    v_cvt_pk_bf16_f32 v201, v142, v143
    v_cvt_pk_bf16_f32 v202, v144, v145
    v_cvt_pk_bf16_f32 v203, v146, v147
    s_add_u32 s47, s57, 5120
    buffer_store_dwordx4 v[200:203], v212, s[24:27], s47 offen
    v_cvt_pk_bf16_f32 v204, v148, v149
    v_cvt_pk_bf16_f32 v205, v150, v151
    v_cvt_pk_bf16_f32 v206, v152, v153
    v_cvt_pk_bf16_f32 v207, v154, v155
    s_add_u32 s47, s57, 9216
    buffer_store_dwordx4 v[204:207], v212, s[24:27], s47 offen
    v_cvt_pk_bf16_f32 v208, v156, v157
    v_cvt_pk_bf16_f32 v209, v158, v159
    v_cvt_pk_bf16_f32 v210, v160, v161
    v_cvt_pk_bf16_f32 v211, v162, v163
    s_add_u32 s47, s57, 13312
    buffer_store_dwordx4 v[208:211], v212, s[24:27], s47 offen
    v_lshlrev_b32 v164, 16, v12
    v_and_b32 v165, 0xffff0000, v12
    v_lshlrev_b32 v166, 16, v13
    v_and_b32 v167, 0xffff0000, v13
    v_lshlrev_b32 v168, 16, v14
    v_and_b32 v169, 0xffff0000, v14
    v_lshlrev_b32 v170, 16, v15
    v_and_b32 v171, 0xffff0000, v15
    v_add_f32 v172, v164, v165
    v_add_f32 v172, v172, v166
    v_add_f32 v172, v172, v167
    v_add_f32 v172, v172, v168
    v_add_f32 v172, v172, v169
    v_add_f32 v172, v172, v170
    v_add_f32 v172, v172, v171
    s_nop 1
    v_add_f32_dpp v172, v172, v172 quad_perm:[1,0,3,2] row_mask:0xf bank_mask:0xf
    s_nop 1
    v_add_f32_dpp v172, v172, v172 quad_perm:[2,3,0,1] row_mask:0xf bank_mask:0xf
    s_nop 1
    v_add_f32_dpp v172, v172, v172 row_half_mirror row_mask:0xf bank_mask:0xf
    s_nop 1
    v_add_f32_dpp v172, v172, v172 row_mirror row_mask:0xf bank_mask:0xf
    v_mov_b32 v174, v172
    s_nop 1
    v_permlane16_swap_b32 v172, v174
    s_nop 1
    v_add_f32 v172, v172, v174
    v_mov_b32 v174, v172
    s_nop 1
    v_permlane32_swap_b32 v172, v174
    s_nop 1
    v_add_f32 v172, v172, v174
    v_mul_f32 v172, 0x3b000000, v172
    v_sub_f32 v164, v164, v172
    v_sub_f32 v165, v165, v172
    v_sub_f32 v166, v166, v172
    v_sub_f32 v167, v167, v172
    v_sub_f32 v168, v168, v172
    v_sub_f32 v169, v169, v172
    v_sub_f32 v170, v170, v172
    v_sub_f32 v171, v171, v172
    v_mul_f32 v173, v164, v164
    v_fmac_f32 v173, v165, v165
    v_fmac_f32 v173, v166, v166
    v_fmac_f32 v173, v167, v167
    v_fmac_f32 v173, v168, v168
    v_fmac_f32 v173, v169, v169
    v_fmac_f32 v173, v170, v170
    v_fmac_f32 v173, v171, v171
    s_nop 1
    v_add_f32_dpp v173, v173, v173 quad_perm:[1,0,3,2] row_mask:0xf bank_mask:0xf
    s_nop 1
    v_add_f32_dpp v173, v173, v173 quad_perm:[2,3,0,1] row_mask:0xf bank_mask:0xf
    s_nop 1
    v_add_f32_dpp v173, v173, v173 row_half_mirror row_mask:0xf bank_mask:0xf
    s_nop 1
    v_add_f32_dpp v173, v173, v173 row_mirror row_mask:0xf bank_mask:0xf
    v_mov_b32 v174, v173
    s_nop 1
    v_permlane16_swap_b32 v173, v174
    s_nop 1
    v_add_f32 v173, v173, v174
    v_mov_b32 v174, v173
    s_nop 1
    v_permlane32_swap_b32 v173, v174
    s_nop 1
    v_add_f32 v173, v173, v174
    v_mov_b32 v174, 0x3727c5ac
    v_fmac_f32 v174, 0x3b000000, v173
    v_rsq_f32 v174, v174
    s_nop 0
    v_mul_f32 v174, 0x3e0293ee, v174
    v_mul_f32 v164, v164, v174
    v_mul_f32 v165, v165, v174
    v_mul_f32 v166, v166, v174
    v_mul_f32 v167, v167, v174
    v_mul_f32 v168, v168, v174
    v_mul_f32 v169, v169, v174
    v_mul_f32 v170, v170, v174
    v_mul_f32 v171, v171, v174
    v_cvt_pk_bf16_f32 v12, v164, v165
    v_cvt_pk_bf16_f32 v13, v166, v167
    v_cvt_pk_bf16_f32 v14, v168, v169
    v_cvt_pk_bf16_f32 v15, v170, v171
    v_lshrrev_b32 v172, 1, v1
    v_lshlrev_b32 v172, 10, v172
    v_and_b32 v173, 1, v1
    v_lshl_add_u32 v172, v173, 9, v172
    s_lshr_b32 s40, s40, 10
    s_lshr_b32 s41, s40, 5
    s_lshl_b32 s41, s41, 15
    s_and_b32 s40, s40, 31
    s_lshl_b32 s40, s40, 4
    s_add_u32 s40, s40, s41
    buffer_store_dwordx4 v[12:15], v172, s[32:35], s40 offen
.Lkvproj_end_1:
    s_endpgm
.globl attn_kernel
.p2align 8
.type attn_kernel,@function
attn_kernel:
    s_cmp_ge_u32 s2, 256
    s_cbranch_scc1 .Lattn_k_end_1
    v_and_b32 v1, 63, v0
    v_lshrrev_b32 v2, 6, v0
    s_nop 0
    v_readfirstlane_b32 s3, v2
    s_load_dwordx2 s[8:9], s[0:1], 104
    s_load_dwordx2 s[80:81], s[0:1], 16
    s_load_dwordx2 s[12:13], s[0:1], 104
    s_load_dwordx2 s[16:17], s[0:1], 104
    s_load_dwordx2 s[20:21], s[0:1], 104
    s_load_dwordx2 s[24:25], s[0:1], 40
    s_load_dwordx2 s[28:29], s[0:1], 56
    s_load_dwordx2 s[32:33], s[0:1], 72
    s_waitcnt lgkmcnt(0)
    s_and_b32 s9, s9, 0xffff
    s_mov_b32 s10, 0x200000
    s_mov_b32 s11, 0x20000
    s_and_b32 s81, s81, 0xffff
    s_mov_b32 s82, 0x400000
    s_mov_b32 s83, 0x20000
    s_add_u32 s12, s12, 0x1200000
    s_addc_u32 s13, s13, 0
    s_and_b32 s13, s13, 0xffff
    s_mov_b32 s14, 0x1000000
    s_mov_b32 s15, 0x20000
    s_add_u32 s16, s16, 0x2200000
    s_addc_u32 s17, s17, 0
    s_and_b32 s17, s17, 0xffff
    s_mov_b32 s18, 0x1000000
    s_mov_b32 s19, 0x20000
    s_add_u32 s20, s20, 0x3200000
    s_addc_u32 s21, s21, 0
    s_and_b32 s21, s21, 0xffff
    s_mov_b32 s22, 0x1000000
    s_mov_b32 s23, 0x20000
    s_and_b32 s25, s25, 0xffff
    s_mov_b32 s26, 0x400000
    s_mov_b32 s27, 0x20000
    s_and_b32 s29, s29, 0xffff
    s_mov_b32 s30, 0x700000
    s_mov_b32 s31, 0x20000
    s_and_b32 s33, s33, 0xffff
    s_mov_b32 s34, 0x700000
    s_mov_b32 s35, 0x20000
    s_mul_i32 s63, s2, 512
    v_add_u32 v3, s63, v0
    v_lshrrev_b32 v3, 1, v3
    v_lshlrev_b32 v3, 7, v3
    s_and_b32 s36, s2, 7
    s_lshl_b32 s36, s36, 2
    s_bfe_u32 s37, s2, 0x20003
    s_add_u32 s36, s36, s37
    s_lshr_b32 s37, s2, 5
    s_lshr_b32 s38, s3, 2
    s_and_b32 s39, s3, 3
    v_lshlrev_b32 v5, 4, v1
    s_lshl_b32 s48, s39, 12
    v_add_u32 v6, s48, v5
    v_and_b32 v9, 31, v1
    s_lshl_b32 s48, s39, 5
    v_add_u32 v9, s48, v9
    s_lshl_b32 s48, s38, 6
    v_subrev_u32 v9, s48, v9
    v_lshrrev_b32 v10, 5, v1
    v_lshlrev_b32 v10, 2, v10
    v_sub_u32 v9, v9, v10
    v_mov_b32 v14, 0xff800000
    s_cmp_lt_u32 s39, 2
    s_cselect_b32 s49, s38, 0
    s_mul_i32 s50, s38, 0xc000
    s_cmp_eq_u32 s38, 0
    s_mov_b32 s88, 0x4000
    s_cselect_b32 s88, s88, 0x1c000
    s_mov_b32 s89, 0x10000
    s_cselect_b32 s89, s89, 0x8000
    s_lshl_b32 s51, s36, 19
    s_lshl_b32 s48, s38, 14
    s_add_u32 s51, s51, s48
    v_lshl_add_u32 v112, v2, 1, 0
    v_lshrrev_b32 v115, 4, v1
    v_and_b32 v116, 15, v1
    v_mul_u32_u24 v117, 4, v112
    v_add_u32 v115, v115, v117
    v_and_b32 v117, 3, v115
    v_lshlrev_b32 v117, 2, v117
    v_xor_b32 v116, v116, v117
    v_lshlrev_b32 v116, 4, v116
    s_mov_b32 s60, 8192
    v_mul_lo_u32 v113, s60, v115
    v_add_u32 v113, v113, v116
    v_lshl_add_u32 v112, v2, 1, 1
    v_lshrrev_b32 v115, 4, v1
    v_and_b32 v116, 15, v1
    v_mul_u32_u24 v117, 4, v112
    v_add_u32 v115, v115, v117
    v_and_b32 v117, 3, v115
    v_lshlrev_b32 v117, 2, v117
    v_xor_b32 v116, v116, v117
    v_lshlrev_b32 v116, 4, v116
    s_mov_b32 s60, 8192
    v_mul_lo_u32 v114, s60, v115
    v_add_u32 v114, v114, v116
    s_sub_u32 s42, 15, s37
    s_cmp_eq_u32 s38, 0
    s_cselect_b32 s84, s42, s37
    s_lshl_b32 s84, s84, 2
    s_add_u32 s84, s84, s39
    s_lshl_b32 s84, s84, 15
    s_lshl_b32 s85, s36, 8
    s_lshl_b32 s87, s3, 11
    v_bfe_u32 v123, v1, 2, 2
    v_lshrrev_b32 v124, 5, v1
    v_lshlrev_b32 v124, 3, v124
    v_add_u32 v124, v124, v123
    v_mul_u32_u24 v115, 256, v124
    v_xor_b32 v123, 0, v123
    v_lshlrev_b32 v123, 6, v123
    v_add_u32 v115, v115, v123
    v_bfe_u32 v123, v1, 4, 1
    v_lshlrev_b32 v123, 5, v123
    v_add_u32 v115, v115, v123
    v_and_b32 v123, 3, v1
    v_lshlrev_b32 v123, 3, v123
    v_add_u32 v115, v115, v123
    v_add_u32 v116, 0x10000, v115
    v_bfe_u32 v123, v1, 2, 2
    v_lshrrev_b32 v124, 5, v1
    v_lshlrev_b32 v124, 3, v124
    v_add_u32 v124, v124, v123
    v_mul_u32_u24 v117, 256, v124
    v_xor_b32 v123, 1, v123
    v_lshlrev_b32 v123, 6, v123
    v_add_u32 v117, v117, v123
    v_bfe_u32 v123, v1, 4, 1
    v_lshlrev_b32 v123, 5, v123
    v_add_u32 v117, v117, v123
    v_and_b32 v123, 3, v1
    v_lshlrev_b32 v123, 3, v123
    v_add_u32 v117, v117, v123
    v_add_u32 v118, 0x10000, v117
    v_bfe_u32 v123, v1, 2, 2
    v_lshrrev_b32 v124, 5, v1
    v_lshlrev_b32 v124, 3, v124
    v_add_u32 v124, v124, v123
    v_mul_u32_u24 v119, 256, v124
    v_xor_b32 v123, 2, v123
    v_lshlrev_b32 v123, 6, v123
    v_add_u32 v119, v119, v123
    v_bfe_u32 v123, v1, 4, 1
    v_lshlrev_b32 v123, 5, v123
    v_add_u32 v119, v119, v123
    v_and_b32 v123, 3, v1
    v_lshlrev_b32 v123, 3, v123
    v_add_u32 v119, v119, v123
    v_add_u32 v120, 0x10000, v119
    v_bfe_u32 v123, v1, 2, 2
    v_lshrrev_b32 v124, 5, v1
    v_lshlrev_b32 v124, 3, v124
    v_add_u32 v124, v124, v123
    v_mul_u32_u24 v121, 256, v124
    v_xor_b32 v123, 3, v123
    v_lshlrev_b32 v123, 6, v123
    v_add_u32 v121, v121, v123
    v_bfe_u32 v123, v1, 4, 1
    v_lshlrev_b32 v123, 5, v123
    v_add_u32 v121, v121, v123
    v_and_b32 v123, 3, v1
    v_lshlrev_b32 v123, 3, v123
    v_add_u32 v121, v121, v123
    v_add_u32 v122, 0x10000, v121
    v_mov_b32 v48, 0
    v_mov_b32 v49, 0
    v_mov_b32 v50, 0
    v_mov_b32 v51, 0
    v_mov_b32 v52, 0
    v_mov_b32 v53, 0
    v_mov_b32 v54, 0
    v_mov_b32 v55, 0
    v_mov_b32 v56, 0
    v_mov_b32 v57, 0
    v_mov_b32 v58, 0
    v_mov_b32 v59, 0
    v_mov_b32 v60, 0
    v_mov_b32 v61, 0
    v_mov_b32 v62, 0
    v_mov_b32 v63, 0
    v_mov_b32 v64, 0
    v_mov_b32 v65, 0
    v_mov_b32 v66, 0
    v_mov_b32 v67, 0
    v_mov_b32 v68, 0
    v_mov_b32 v69, 0
    v_mov_b32 v70, 0
    v_mov_b32 v71, 0
    v_mov_b32 v72, 0
    v_mov_b32 v73, 0
    v_mov_b32 v74, 0
    v_mov_b32 v75, 0
    v_mov_b32 v76, 0
    v_mov_b32 v77, 0
    v_mov_b32 v78, 0
    v_mov_b32 v79, 0
    v_mov_b32 v80, 0
    v_mov_b32 v81, 0
    v_mov_b32 v82, 0
    v_mov_b32 v83, 0
    v_mov_b32 v84, 0
    v_mov_b32 v85, 0
    v_mov_b32 v86, 0
    v_mov_b32 v87, 0
    v_mov_b32 v88, 0
    v_mov_b32 v89, 0
    v_mov_b32 v90, 0
    v_mov_b32 v91, 0
    v_mov_b32 v92, 0
    v_mov_b32 v93, 0
    v_mov_b32 v94, 0
    v_mov_b32 v95, 0
    v_mov_b32 v96, 0
    v_mov_b32 v97, 0
    v_mov_b32 v98, 0
    v_mov_b32 v99, 0
    v_mov_b32 v100, 0
    v_mov_b32 v101, 0
    v_mov_b32 v102, 0
    v_mov_b32 v103, 0
    v_mov_b32 v104, 0
    v_mov_b32 v105, 0
    v_mov_b32 v106, 0
    v_mov_b32 v107, 0
    v_mov_b32 v108, 0
    v_mov_b32 v109, 0
    v_mov_b32 v110, 0
    v_mov_b32 v111, 0
    s_add_u32 m0, s87, 0x4000
    s_nop 0
    buffer_load_dwordx4 v113, s[80:83], s85 offen lds
    s_add_u32 m0, s87, 0x4400
    s_nop 0
    buffer_load_dwordx4 v114, s[80:83], s85 offen lds
    buffer_load_dwordx4 v[16:19], v5, s[8:11], s84 offen offset:0
    buffer_load_dwordx4 v[20:23], v5, s[8:11], s84 offen offset:1024
    buffer_load_dwordx4 v[24:27], v5, s[8:11], s84 offen offset:2048
    buffer_load_dwordx4 v[28:31], v5, s[8:11], s84 offen offset:3072
    s_add_u32 s84, s84, 4096
    s_add_u32 s85, s85, 0x80000
    s_add_u32 m0, s87, 0x10000
    s_nop 0
    buffer_load_dwordx4 v113, s[80:83], s85 offen lds
    s_add_u32 m0, s87, 0x10400
    s_nop 0
    buffer_load_dwordx4 v114, s[80:83], s85 offen lds
    buffer_load_dwordx4 v[32:35], v5, s[8:11], s84 offen offset:0
    buffer_load_dwordx4 v[36:39], v5, s[8:11], s84 offen offset:1024
    buffer_load_dwordx4 v[40:43], v5, s[8:11], s84 offen offset:2048
    buffer_load_dwordx4 v[44:47], v5, s[8:11], s84 offen offset:3072
    s_add_u32 s84, s84, 4096
    s_add_u32 s85, s85, 0x80000
    s_lshl_b32 s48, s39, 12
    s_add_u32 s45, s50, s48
    s_add_u32 s46, s45, 0x8000
    s_mov_b32 s43, s51
    s_mov_b32 s44, s51
    s_mov_b32 s14, 0x1000000
    s_mov_b32 m0, s45
    s_nop 0
    buffer_load_dwordx4 v6, s[12:15], s43 offen offset:0 lds
    buffer_load_dwordx4 v6, s[12:15], s43 offen offset:1024 lds
    buffer_load_dwordx4 v6, s[12:15], s43 offen offset:2048 lds
    buffer_load_dwordx4 v6, s[12:15], s43 offen offset:3072 lds
    s_mov_b32 m0, s46
    s_nop 0
    buffer_load_dwordx4 v6, s[16:19], s44 offen offset:0 lds
    buffer_load_dwordx4 v6, s[16:19], s44 offen offset:1024 lds
    buffer_load_dwordx4 v6, s[16:19], s44 offen offset:2048 lds
    buffer_load_dwordx4 v6, s[16:19], s44 offen offset:3072 lds
    s_add_u32 s43, s43, 0x8000
    s_add_u32 s44, s44, 0x8000
    s_xor_b32 s45, s45, s88
    s_xor_b32 s46, s46, s89
    s_waitcnt vmcnt(14) lgkmcnt(0)
    s_barrier
    ds_read_b64_tr_b16 v[160:161], v115 offset:16384
    ds_read_b64_tr_b16 v[162:163], v115 offset:17408
    ds_read_b64_tr_b16 v[164:165], v117 offset:16384
    ds_read_b64_tr_b16 v[166:167], v117 offset:17408
    ds_read_b64_tr_b16 v[168:169], v119 offset:16384
    ds_read_b64_tr_b16 v[170:171], v119 offset:17408
    ds_read_b64_tr_b16 v[172:173], v121 offset:16384
    ds_read_b64_tr_b16 v[174:175], v121 offset:17408
    s_waitcnt lgkmcnt(0)
    v_mfma_f32_32x32x16_bf16 v[48:63], v[160:163], v[16:19], v[48:63]
    ds_read_b64_tr_b16 v[176:177], v115 offset:20480
    ds_read_b64_tr_b16 v[178:179], v115 offset:21504
    ds_read_b64_tr_b16 v[180:181], v117 offset:20480
    v_mfma_f32_32x32x16_bf16 v[64:79], v[164:167], v[16:19], v[64:79]
    ds_read_b64_tr_b16 v[182:183], v117 offset:21504
    ds_read_b64_tr_b16 v[184:185], v119 offset:20480
    ds_read_b64_tr_b16 v[186:187], v119 offset:21504
    s_add_u32 m0, s87, 0x18000
    s_nop 0
    buffer_load_dwordx4 v113, s[80:83], s85 offen lds
    v_mfma_f32_32x32x16_bf16 v[80:95], v[168:171], v[16:19], v[80:95]
    ds_read_b64_tr_b16 v[188:189], v121 offset:20480
    ds_read_b64_tr_b16 v[190:191], v121 offset:21504
    s_add_u32 m0, s87, 0x18400
    s_nop 0
    buffer_load_dwordx4 v114, s[80:83], s85 offen lds
    v_mfma_f32_32x32x16_bf16 v[96:111], v[172:175], v[16:19], v[96:111]
    buffer_load_dwordx4 v[144:147], v5, s[8:11], s84 offen offset:0
    buffer_load_dwordx4 v[148:151], v5, s[8:11], s84 offen offset:1024
    buffer_load_dwordx4 v[152:155], v5, s[8:11], s84 offen offset:2048
    s_waitcnt lgkmcnt(0)
    v_mfma_f32_32x32x16_bf16 v[48:63], v[176:179], v[20:23], v[48:63]
    ds_read_b64_tr_b16 v[160:161], v115 offset:24576
    ds_read_b64_tr_b16 v[162:163], v115 offset:25600
    ds_read_b64_tr_b16 v[164:165], v117 offset:24576
    v_mfma_f32_32x32x16_bf16 v[64:79], v[180:183], v[20:23], v[64:79]
    ds_read_b64_tr_b16 v[166:167], v117 offset:25600
    ds_read_b64_tr_b16 v[168:169], v119 offset:24576
    ds_read_b64_tr_b16 v[170:171], v119 offset:25600
    buffer_load_dwordx4 v[156:159], v5, s[8:11], s84 offen offset:3072
    s_add_u32 s84, s84, 4096
    v_mfma_f32_32x32x16_bf16 v[80:95], v[184:187], v[20:23], v[80:95]
    ds_read_b64_tr_b16 v[172:173], v121 offset:24576
    ds_read_b64_tr_b16 v[174:175], v121 offset:25600
    s_add_u32 s85, s85, 0x80000
    v_mfma_f32_32x32x16_bf16 v[96:111], v[188:191], v[20:23], v[96:111]
    s_waitcnt lgkmcnt(0)
    v_mfma_f32_32x32x16_bf16 v[48:63], v[160:163], v[24:27], v[48:63]
    ds_read_b64_tr_b16 v[176:177], v115 offset:28672
    ds_read_b64_tr_b16 v[178:179], v115 offset:29696
    ds_read_b64_tr_b16 v[180:181], v117 offset:28672
    v_mfma_f32_32x32x16_bf16 v[64:79], v[164:167], v[24:27], v[64:79]
    ds_read_b64_tr_b16 v[182:183], v117 offset:29696
    ds_read_b64_tr_b16 v[184:185], v119 offset:28672
    ds_read_b64_tr_b16 v[186:187], v119 offset:29696
    v_mfma_f32_32x32x16_bf16 v[80:95], v[168:171], v[24:27], v[80:95]
    ds_read_b64_tr_b16 v[188:189], v121 offset:28672
    ds_read_b64_tr_b16 v[190:191], v121 offset:29696
    v_mfma_f32_32x32x16_bf16 v[96:111], v[172:175], v[24:27], v[96:111]
    s_waitcnt vmcnt(14) lgkmcnt(0)
    s_barrier
    v_mfma_f32_32x32x16_bf16 v[48:63], v[176:179], v[28:31], v[48:63]
    ds_read_b64_tr_b16 v[160:161], v116 offset:0
    ds_read_b64_tr_b16 v[162:163], v116 offset:1024
    ds_read_b64_tr_b16 v[164:165], v118 offset:0
    v_mfma_f32_32x32x16_bf16 v[64:79], v[180:183], v[28:31], v[64:79]
    ds_read_b64_tr_b16 v[166:167], v118 offset:1024
    ds_read_b64_tr_b16 v[168:169], v120 offset:0
    ds_read_b64_tr_b16 v[170:171], v120 offset:1024
    s_add_u32 m0, s87, 0x4000
    s_nop 0
    buffer_load_dwordx4 v113, s[80:83], s85 offen lds
    v_mfma_f32_32x32x16_bf16 v[80:95], v[184:187], v[28:31], v[80:95]
    ds_read_b64_tr_b16 v[172:173], v122 offset:0
    ds_read_b64_tr_b16 v[174:175], v122 offset:1024
    s_add_u32 m0, s87, 0x4400
    s_nop 0
    buffer_load_dwordx4 v114, s[80:83], s85 offen lds
    v_mfma_f32_32x32x16_bf16 v[96:111], v[188:191], v[28:31], v[96:111]
    buffer_load_dwordx4 v[192:195], v5, s[8:11], s84 offen offset:0
    buffer_load_dwordx4 v[196:199], v5, s[8:11], s84 offen offset:1024
    buffer_load_dwordx4 v[200:203], v5, s[8:11], s84 offen offset:2048
    s_waitcnt lgkmcnt(0)
    v_mfma_f32_32x32x16_bf16 v[48:63], v[160:163], v[32:35], v[48:63]
    ds_read_b64_tr_b16 v[176:177], v116 offset:4096
    ds_read_b64_tr_b16 v[178:179], v116 offset:5120
    ds_read_b64_tr_b16 v[180:181], v118 offset:4096
    v_mfma_f32_32x32x16_bf16 v[64:79], v[164:167], v[32:35], v[64:79]
    ds_read_b64_tr_b16 v[182:183], v118 offset:5120
    ds_read_b64_tr_b16 v[184:185], v120 offset:4096
    ds_read_b64_tr_b16 v[186:187], v120 offset:5120
    buffer_load_dwordx4 v[204:207], v5, s[8:11], s84 offen offset:3072
    s_add_u32 s84, s84, 4096
    v_mfma_f32_32x32x16_bf16 v[80:95], v[168:171], v[32:35], v[80:95]
    ds_read_b64_tr_b16 v[188:189], v122 offset:4096
    ds_read_b64_tr_b16 v[190:191], v122 offset:5120
    s_add_u32 s85, s85, 0x80000
    v_mfma_f32_32x32x16_bf16 v[96:111], v[172:175], v[32:35], v[96:111]
    s_waitcnt lgkmcnt(0)
    v_mfma_f32_32x32x16_bf16 v[48:63], v[176:179], v[36:39], v[48:63]
    ds_read_b64_tr_b16 v[160:161], v116 offset:8192
    ds_read_b64_tr_b16 v[162:163], v116 offset:9216
    ds_read_b64_tr_b16 v[164:165], v118 offset:8192
    v_mfma_f32_32x32x16_bf16 v[64:79], v[180:183], v[36:39], v[64:79]
    ds_read_b64_tr_b16 v[166:167], v118 offset:9216
    ds_read_b64_tr_b16 v[168:169], v120 offset:8192
    ds_read_b64_tr_b16 v[170:171], v120 offset:9216
    v_mfma_f32_32x32x16_bf16 v[80:95], v[184:187], v[36:39], v[80:95]
    ds_read_b64_tr_b16 v[172:173], v122 offset:8192
    ds_read_b64_tr_b16 v[174:175], v122 offset:9216
    v_mfma_f32_32x32x16_bf16 v[96:111], v[188:191], v[36:39], v[96:111]
    s_waitcnt lgkmcnt(0)
    v_mfma_f32_32x32x16_bf16 v[48:63], v[160:163], v[40:43], v[48:63]
    ds_read_b64_tr_b16 v[176:177], v116 offset:12288
    ds_read_b64_tr_b16 v[178:179], v116 offset:13312
    ds_read_b64_tr_b16 v[180:181], v118 offset:12288
    v_mfma_f32_32x32x16_bf16 v[64:79], v[164:167], v[40:43], v[64:79]
    ds_read_b64_tr_b16 v[182:183], v118 offset:13312
    ds_read_b64_tr_b16 v[184:185], v120 offset:12288
    ds_read_b64_tr_b16 v[186:187], v120 offset:13312
    v_mfma_f32_32x32x16_bf16 v[80:95], v[168:171], v[40:43], v[80:95]
    ds_read_b64_tr_b16 v[188:189], v122 offset:12288
    ds_read_b64_tr_b16 v[190:191], v122 offset:13312
    v_mfma_f32_32x32x16_bf16 v[96:111], v[172:175], v[40:43], v[96:111]
    s_waitcnt vmcnt(6) lgkmcnt(0)
    s_barrier
    v_mfma_f32_32x32x16_bf16 v[48:63], v[176:179], v[44:47], v[48:63]
    ds_read_b64_tr_b16 v[160:161], v116 offset:32768
    ds_read_b64_tr_b16 v[162:163], v116 offset:33792
    ds_read_b64_tr_b16 v[164:165], v118 offset:32768
    v_mfma_f32_32x32x16_bf16 v[64:79], v[180:183], v[44:47], v[64:79]
    ds_read_b64_tr_b16 v[166:167], v118 offset:33792
    ds_read_b64_tr_b16 v[168:169], v120 offset:32768
    ds_read_b64_tr_b16 v[170:171], v120 offset:33792
    s_add_u32 m0, s87, 0x10000
    s_nop 0
    buffer_load_dwordx4 v113, s[80:83], s85 offen lds
    v_mfma_f32_32x32x16_bf16 v[80:95], v[184:187], v[44:47], v[80:95]
    ds_read_b64_tr_b16 v[172:173], v122 offset:32768
    ds_read_b64_tr_b16 v[174:175], v122 offset:33792
    s_add_u32 m0, s87, 0x10400
    s_nop 0
    buffer_load_dwordx4 v114, s[80:83], s85 offen lds
    v_mfma_f32_32x32x16_bf16 v[96:111], v[188:191], v[44:47], v[96:111]
    buffer_load_dwordx4 v[16:19], v5, s[8:11], s84 offen offset:0
    buffer_load_dwordx4 v[20:23], v5, s[8:11], s84 offen offset:1024
    buffer_load_dwordx4 v[24:27], v5, s[8:11], s84 offen offset:2048
    s_waitcnt lgkmcnt(0)
    v_mfma_f32_32x32x16_bf16 v[48:63], v[160:163], v[144:147], v[48:63]
    ds_read_b64_tr_b16 v[176:177], v116 offset:36864
    ds_read_b64_tr_b16 v[178:179], v116 offset:37888
    ds_read_b64_tr_b16 v[180:181], v118 offset:36864
    v_mfma_f32_32x32x16_bf16 v[64:79], v[164:167], v[144:147], v[64:79]
    ds_read_b64_tr_b16 v[182:183], v118 offset:37888
    ds_read_b64_tr_b16 v[184:185], v120 offset:36864
    ds_read_b64_tr_b16 v[186:187], v120 offset:37888
    buffer_load_dwordx4 v[28:31], v5, s[8:11], s84 offen offset:3072
    s_add_u32 s84, s84, 4096
    v_mfma_f32_32x32x16_bf16 v[80:95], v[168:171], v[144:147], v[80:95]
    ds_read_b64_tr_b16 v[188:189], v122 offset:36864
    ds_read_b64_tr_b16 v[190:191], v122 offset:37888
    s_add_u32 s85, s85, 0x80000
    v_mfma_f32_32x32x16_bf16 v[96:111], v[172:175], v[144:147], v[96:111]
    s_waitcnt lgkmcnt(0)
    v_mfma_f32_32x32x16_bf16 v[48:63], v[176:179], v[148:151], v[48:63]
    ds_read_b64_tr_b16 v[160:161], v116 offset:40960
    ds_read_b64_tr_b16 v[162:163], v116 offset:41984
    ds_read_b64_tr_b16 v[164:165], v118 offset:40960
    v_mfma_f32_32x32x16_bf16 v[64:79], v[180:183], v[148:151], v[64:79]
    ds_read_b64_tr_b16 v[166:167], v118 offset:41984
    ds_read_b64_tr_b16 v[168:169], v120 offset:40960
    ds_read_b64_tr_b16 v[170:171], v120 offset:41984
    v_mfma_f32_32x32x16_bf16 v[80:95], v[184:187], v[148:151], v[80:95]
    ds_read_b64_tr_b16 v[172:173], v122 offset:40960
    ds_read_b64_tr_b16 v[174:175], v122 offset:41984
    v_mfma_f32_32x32x16_bf16 v[96:111], v[188:191], v[148:151], v[96:111]
    s_waitcnt lgkmcnt(0)
    v_mfma_f32_32x32x16_bf16 v[48:63], v[160:163], v[152:155], v[48:63]
    ds_read_b64_tr_b16 v[176:177], v116 offset:45056
    ds_read_b64_tr_b16 v[178:179], v116 offset:46080
    ds_read_b64_tr_b16 v[180:181], v118 offset:45056
    v_mfma_f32_32x32x16_bf16 v[64:79], v[164:167], v[152:155], v[64:79]
    ds_read_b64_tr_b16 v[182:183], v118 offset:46080
    ds_read_b64_tr_b16 v[184:185], v120 offset:45056
    ds_read_b64_tr_b16 v[186:187], v120 offset:46080
    v_mfma_f32_32x32x16_bf16 v[80:95], v[168:171], v[152:155], v[80:95]
    ds_read_b64_tr_b16 v[188:189], v122 offset:45056
    ds_read_b64_tr_b16 v[190:191], v122 offset:46080
    v_mfma_f32_32x32x16_bf16 v[96:111], v[172:175], v[152:155], v[96:111]
    s_waitcnt vmcnt(6) lgkmcnt(0)
    s_barrier
    v_mfma_f32_32x32x16_bf16 v[48:63], v[176:179], v[156:159], v[48:63]
    ds_read_b64_tr_b16 v[160:161], v115 offset:16384
    ds_read_b64_tr_b16 v[162:163], v115 offset:17408
    ds_read_b64_tr_b16 v[164:165], v117 offset:16384
    v_mfma_f32_32x32x16_bf16 v[64:79], v[180:183], v[156:159], v[64:79]
    ds_read_b64_tr_b16 v[166:167], v117 offset:17408
    ds_read_b64_tr_b16 v[168:169], v119 offset:16384
    ds_read_b64_tr_b16 v[170:171], v119 offset:17408
    s_add_u32 m0, s87, 0x18000
    s_nop 0
    buffer_load_dwordx4 v113, s[80:83], s85 offen lds
    v_mfma_f32_32x32x16_bf16 v[80:95], v[184:187], v[156:159], v[80:95]
    ds_read_b64_tr_b16 v[172:173], v121 offset:16384
    ds_read_b64_tr_b16 v[174:175], v121 offset:17408
    s_add_u32 m0, s87, 0x18400
    s_nop 0
    buffer_load_dwordx4 v114, s[80:83], s85 offen lds
    v_mfma_f32_32x32x16_bf16 v[96:111], v[188:191], v[156:159], v[96:111]
    buffer_load_dwordx4 v[32:35], v5, s[8:11], s84 offen offset:0
    buffer_load_dwordx4 v[36:39], v5, s[8:11], s84 offen offset:1024
    buffer_load_dwordx4 v[40:43], v5, s[8:11], s84 offen offset:2048
    s_waitcnt lgkmcnt(0)
    v_mfma_f32_32x32x16_bf16 v[48:63], v[160:163], v[192:195], v[48:63]
    ds_read_b64_tr_b16 v[176:177], v115 offset:20480
    ds_read_b64_tr_b16 v[178:179], v115 offset:21504
    ds_read_b64_tr_b16 v[180:181], v117 offset:20480
    v_mfma_f32_32x32x16_bf16 v[64:79], v[164:167], v[192:195], v[64:79]
    ds_read_b64_tr_b16 v[182:183], v117 offset:21504
    ds_read_b64_tr_b16 v[184:185], v119 offset:20480
    ds_read_b64_tr_b16 v[186:187], v119 offset:21504
    buffer_load_dwordx4 v[44:47], v5, s[8:11], s84 offen offset:3072
    s_add_u32 s84, s84, 4096
    v_mfma_f32_32x32x16_bf16 v[80:95], v[168:171], v[192:195], v[80:95]
    ds_read_b64_tr_b16 v[188:189], v121 offset:20480
    ds_read_b64_tr_b16 v[190:191], v121 offset:21504
    s_add_u32 s85, s85, 0x80000
    v_mfma_f32_32x32x16_bf16 v[96:111], v[172:175], v[192:195], v[96:111]
    s_waitcnt lgkmcnt(0)
    v_mfma_f32_32x32x16_bf16 v[48:63], v[176:179], v[196:199], v[48:63]
    ds_read_b64_tr_b16 v[160:161], v115 offset:24576
    ds_read_b64_tr_b16 v[162:163], v115 offset:25600
    ds_read_b64_tr_b16 v[164:165], v117 offset:24576
    v_mfma_f32_32x32x16_bf16 v[64:79], v[180:183], v[196:199], v[64:79]
    ds_read_b64_tr_b16 v[166:167], v117 offset:25600
    ds_read_b64_tr_b16 v[168:169], v119 offset:24576
    ds_read_b64_tr_b16 v[170:171], v119 offset:25600
    v_mfma_f32_32x32x16_bf16 v[80:95], v[184:187], v[196:199], v[80:95]
    ds_read_b64_tr_b16 v[172:173], v121 offset:24576
    ds_read_b64_tr_b16 v[174:175], v121 offset:25600
    v_mfma_f32_32x32x16_bf16 v[96:111], v[188:191], v[196:199], v[96:111]
    s_waitcnt lgkmcnt(0)
    v_mfma_f32_32x32x16_bf16 v[48:63], v[160:163], v[200:203], v[48:63]
    ds_read_b64_tr_b16 v[176:177], v115 offset:28672
    ds_read_b64_tr_b16 v[178:179], v115 offset:29696
    ds_read_b64_tr_b16 v[180:181], v117 offset:28672
    v_mfma_f32_32x32x16_bf16 v[64:79], v[164:167], v[200:203], v[64:79]
    ds_read_b64_tr_b16 v[182:183], v117 offset:29696
    ds_read_b64_tr_b16 v[184:185], v119 offset:28672
    ds_read_b64_tr_b16 v[186:187], v119 offset:29696
    v_mfma_f32_32x32x16_bf16 v[80:95], v[168:171], v[200:203], v[80:95]
    ds_read_b64_tr_b16 v[188:189], v121 offset:28672
    ds_read_b64_tr_b16 v[190:191], v121 offset:29696
    v_mfma_f32_32x32x16_bf16 v[96:111], v[172:175], v[200:203], v[96:111]
    s_waitcnt vmcnt(6) lgkmcnt(0)
    s_barrier
    v_mfma_f32_32x32x16_bf16 v[48:63], v[176:179], v[204:207], v[48:63]
    ds_read_b64_tr_b16 v[160:161], v116 offset:0
    ds_read_b64_tr_b16 v[162:163], v116 offset:1024
    ds_read_b64_tr_b16 v[164:165], v118 offset:0
    v_mfma_f32_32x32x16_bf16 v[64:79], v[180:183], v[204:207], v[64:79]
    ds_read_b64_tr_b16 v[166:167], v118 offset:1024
    ds_read_b64_tr_b16 v[168:169], v120 offset:0
    ds_read_b64_tr_b16 v[170:171], v120 offset:1024
    s_add_u32 m0, s87, 0x4000
    s_nop 0
    buffer_load_dwordx4 v113, s[80:83], s85 offen lds
    v_mfma_f32_32x32x16_bf16 v[80:95], v[184:187], v[204:207], v[80:95]
    ds_read_b64_tr_b16 v[172:173], v122 offset:0
    ds_read_b64_tr_b16 v[174:175], v122 offset:1024
    s_add_u32 m0, s87, 0x4400
    s_nop 0
    buffer_load_dwordx4 v114, s[80:83], s85 offen lds
    v_mfma_f32_32x32x16_bf16 v[96:111], v[188:191], v[204:207], v[96:111]
    buffer_load_dwordx4 v[144:147], v5, s[8:11], s84 offen offset:0
    buffer_load_dwordx4 v[148:151], v5, s[8:11], s84 offen offset:1024
    buffer_load_dwordx4 v[152:155], v5, s[8:11], s84 offen offset:2048
    s_waitcnt lgkmcnt(0)
    v_mfma_f32_32x32x16_bf16 v[48:63], v[160:163], v[16:19], v[48:63]
    ds_read_b64_tr_b16 v[176:177], v116 offset:4096
    ds_read_b64_tr_b16 v[178:179], v116 offset:5120
    ds_read_b64_tr_b16 v[180:181], v118 offset:4096
    v_mfma_f32_32x32x16_bf16 v[64:79], v[164:167], v[16:19], v[64:79]
    ds_read_b64_tr_b16 v[182:183], v118 offset:5120
    ds_read_b64_tr_b16 v[184:185], v120 offset:4096
    ds_read_b64_tr_b16 v[186:187], v120 offset:5120
    buffer_load_dwordx4 v[156:159], v5, s[8:11], s84 offen offset:3072
    s_add_u32 s84, s84, 4096
    v_mfma_f32_32x32x16_bf16 v[80:95], v[168:171], v[16:19], v[80:95]
    ds_read_b64_tr_b16 v[188:189], v122 offset:4096
    ds_read_b64_tr_b16 v[190:191], v122 offset:5120
    s_add_u32 s85, s85, 0x80000
    v_mfma_f32_32x32x16_bf16 v[96:111], v[172:175], v[16:19], v[96:111]
    s_waitcnt lgkmcnt(0)
    v_mfma_f32_32x32x16_bf16 v[48:63], v[176:179], v[20:23], v[48:63]
    ds_read_b64_tr_b16 v[160:161], v116 offset:8192
    ds_read_b64_tr_b16 v[162:163], v116 offset:9216
    ds_read_b64_tr_b16 v[164:165], v118 offset:8192
    v_mfma_f32_32x32x16_bf16 v[64:79], v[180:183], v[20:23], v[64:79]
    ds_read_b64_tr_b16 v[166:167], v118 offset:9216
    ds_read_b64_tr_b16 v[168:169], v120 offset:8192
    ds_read_b64_tr_b16 v[170:171], v120 offset:9216
    v_mfma_f32_32x32x16_bf16 v[80:95], v[184:187], v[20:23], v[80:95]
    ds_read_b64_tr_b16 v[172:173], v122 offset:8192
    ds_read_b64_tr_b16 v[174:175], v122 offset:9216
    v_mfma_f32_32x32x16_bf16 v[96:111], v[188:191], v[20:23], v[96:111]
    s_waitcnt lgkmcnt(0)
    v_mfma_f32_32x32x16_bf16 v[48:63], v[160:163], v[24:27], v[48:63]
    ds_read_b64_tr_b16 v[176:177], v116 offset:12288
    ds_read_b64_tr_b16 v[178:179], v116 offset:13312
    ds_read_b64_tr_b16 v[180:181], v118 offset:12288
    v_mfma_f32_32x32x16_bf16 v[64:79], v[164:167], v[24:27], v[64:79]
    ds_read_b64_tr_b16 v[182:183], v118 offset:13312
    ds_read_b64_tr_b16 v[184:185], v120 offset:12288
    ds_read_b64_tr_b16 v[186:187], v120 offset:13312
    v_mfma_f32_32x32x16_bf16 v[80:95], v[168:171], v[24:27], v[80:95]
    ds_read_b64_tr_b16 v[188:189], v122 offset:12288
    ds_read_b64_tr_b16 v[190:191], v122 offset:13312
    v_mfma_f32_32x32x16_bf16 v[96:111], v[172:175], v[24:27], v[96:111]
    s_waitcnt vmcnt(6) lgkmcnt(0)
    s_barrier
    v_mfma_f32_32x32x16_bf16 v[48:63], v[176:179], v[28:31], v[48:63]
    ds_read_b64_tr_b16 v[160:161], v116 offset:32768
    ds_read_b64_tr_b16 v[162:163], v116 offset:33792
    ds_read_b64_tr_b16 v[164:165], v118 offset:32768
    v_mfma_f32_32x32x16_bf16 v[64:79], v[180:183], v[28:31], v[64:79]
    ds_read_b64_tr_b16 v[166:167], v118 offset:33792
    ds_read_b64_tr_b16 v[168:169], v120 offset:32768
    ds_read_b64_tr_b16 v[170:171], v120 offset:33792
    s_add_u32 m0, s87, 0x10000
    s_nop 0
    buffer_load_dwordx4 v113, s[80:83], s85 offen lds
    v_mfma_f32_32x32x16_bf16 v[80:95], v[184:187], v[28:31], v[80:95]
    ds_read_b64_tr_b16 v[172:173], v122 offset:32768
    ds_read_b64_tr_b16 v[174:175], v122 offset:33792
    s_add_u32 m0, s87, 0x10400
    s_nop 0
    buffer_load_dwordx4 v114, s[80:83], s85 offen lds
    v_mfma_f32_32x32x16_bf16 v[96:111], v[188:191], v[28:31], v[96:111]
    buffer_load_dwordx4 v[192:195], v5, s[8:11], s84 offen offset:0
    buffer_load_dwordx4 v[196:199], v5, s[8:11], s84 offen offset:1024
    buffer_load_dwordx4 v[200:203], v5, s[8:11], s84 offen offset:2048
    s_waitcnt lgkmcnt(0)
    v_mfma_f32_32x32x16_bf16 v[48:63], v[160:163], v[32:35], v[48:63]
    ds_read_b64_tr_b16 v[176:177], v116 offset:36864
    ds_read_b64_tr_b16 v[178:179], v116 offset:37888
    ds_read_b64_tr_b16 v[180:181], v118 offset:36864
    v_mfma_f32_32x32x16_bf16 v[64:79], v[164:167], v[32:35], v[64:79]
    ds_read_b64_tr_b16 v[182:183], v118 offset:37888
    ds_read_b64_tr_b16 v[184:185], v120 offset:36864
    ds_read_b64_tr_b16 v[186:187], v120 offset:37888
    buffer_load_dwordx4 v[204:207], v5, s[8:11], s84 offen offset:3072
    s_add_u32 s84, s84, 4096
    v_mfma_f32_32x32x16_bf16 v[80:95], v[168:171], v[32:35], v[80:95]
    ds_read_b64_tr_b16 v[188:189], v122 offset:36864
    ds_read_b64_tr_b16 v[190:191], v122 offset:37888
    s_add_u32 s85, s85, 0x80000
    v_mfma_f32_32x32x16_bf16 v[96:111], v[172:175], v[32:35], v[96:111]
    s_waitcnt lgkmcnt(0)
    v_mfma_f32_32x32x16_bf16 v[48:63], v[176:179], v[36:39], v[48:63]
    ds_read_b64_tr_b16 v[160:161], v116 offset:40960
    ds_read_b64_tr_b16 v[162:163], v116 offset:41984
    ds_read_b64_tr_b16 v[164:165], v118 offset:40960
    v_mfma_f32_32x32x16_bf16 v[64:79], v[180:183], v[36:39], v[64:79]
    ds_read_b64_tr_b16 v[166:167], v118 offset:41984
    ds_read_b64_tr_b16 v[168:169], v120 offset:40960
    ds_read_b64_tr_b16 v[170:171], v120 offset:41984
    v_mfma_f32_32x32x16_bf16 v[80:95], v[184:187], v[36:39], v[80:95]
    ds_read_b64_tr_b16 v[172:173], v122 offset:40960
    ds_read_b64_tr_b16 v[174:175], v122 offset:41984
    v_mfma_f32_32x32x16_bf16 v[96:111], v[188:191], v[36:39], v[96:111]
    s_waitcnt lgkmcnt(0)
    v_mfma_f32_32x32x16_bf16 v[48:63], v[160:163], v[40:43], v[48:63]
    ds_read_b64_tr_b16 v[176:177], v116 offset:45056
    ds_read_b64_tr_b16 v[178:179], v116 offset:46080
    ds_read_b64_tr_b16 v[180:181], v118 offset:45056
    v_mfma_f32_32x32x16_bf16 v[64:79], v[164:167], v[40:43], v[64:79]
    ds_read_b64_tr_b16 v[182:183], v118 offset:46080
    ds_read_b64_tr_b16 v[184:185], v120 offset:45056
    ds_read_b64_tr_b16 v[186:187], v120 offset:46080
    v_mfma_f32_32x32x16_bf16 v[80:95], v[168:171], v[40:43], v[80:95]
    ds_read_b64_tr_b16 v[188:189], v122 offset:45056
    ds_read_b64_tr_b16 v[190:191], v122 offset:46080
    v_mfma_f32_32x32x16_bf16 v[96:111], v[172:175], v[40:43], v[96:111]
    s_waitcnt vmcnt(6) lgkmcnt(0)
    s_barrier
    v_mfma_f32_32x32x16_bf16 v[48:63], v[176:179], v[44:47], v[48:63]
    ds_read_b64_tr_b16 v[160:161], v115 offset:16384
    ds_read_b64_tr_b16 v[162:163], v115 offset:17408
    ds_read_b64_tr_b16 v[164:165], v117 offset:16384
    v_mfma_f32_32x32x16_bf16 v[64:79], v[180:183], v[44:47], v[64:79]
    ds_read_b64_tr_b16 v[166:167], v117 offset:17408
    ds_read_b64_tr_b16 v[168:169], v119 offset:16384
    ds_read_b64_tr_b16 v[170:171], v119 offset:17408
    v_mfma_f32_32x32x16_bf16 v[80:95], v[184:187], v[44:47], v[80:95]
    ds_read_b64_tr_b16 v[172:173], v121 offset:16384
    ds_read_b64_tr_b16 v[174:175], v121 offset:17408
    v_mfma_f32_32x32x16_bf16 v[96:111], v[188:191], v[44:47], v[96:111]
    s_waitcnt lgkmcnt(0)
    v_mfma_f32_32x32x16_bf16 v[48:63], v[160:163], v[144:147], v[48:63]
    ds_read_b64_tr_b16 v[176:177], v115 offset:20480
    ds_read_b64_tr_b16 v[178:179], v115 offset:21504
    ds_read_b64_tr_b16 v[180:181], v117 offset:20480
    v_mfma_f32_32x32x16_bf16 v[64:79], v[164:167], v[144:147], v[64:79]
    ds_read_b64_tr_b16 v[182:183], v117 offset:21504
    ds_read_b64_tr_b16 v[184:185], v119 offset:20480
    ds_read_b64_tr_b16 v[186:187], v119 offset:21504
    v_mfma_f32_32x32x16_bf16 v[80:95], v[168:171], v[144:147], v[80:95]
    ds_read_b64_tr_b16 v[188:189], v121 offset:20480
    ds_read_b64_tr_b16 v[190:191], v121 offset:21504
    v_mfma_f32_32x32x16_bf16 v[96:111], v[172:175], v[144:147], v[96:111]
    s_waitcnt lgkmcnt(0)
    v_mfma_f32_32x32x16_bf16 v[48:63], v[176:179], v[148:151], v[48:63]
    ds_read_b64_tr_b16 v[160:161], v115 offset:24576
    ds_read_b64_tr_b16 v[162:163], v115 offset:25600
    ds_read_b64_tr_b16 v[164:165], v117 offset:24576
    v_mfma_f32_32x32x16_bf16 v[64:79], v[180:183], v[148:151], v[64:79]
    ds_read_b64_tr_b16 v[166:167], v117 offset:25600
    ds_read_b64_tr_b16 v[168:169], v119 offset:24576
    ds_read_b64_tr_b16 v[170:171], v119 offset:25600
    v_mfma_f32_32x32x16_bf16 v[80:95], v[184:187], v[148:151], v[80:95]
    ds_read_b64_tr_b16 v[172:173], v121 offset:24576
    ds_read_b64_tr_b16 v[174:175], v121 offset:25600
    v_mfma_f32_32x32x16_bf16 v[96:111], v[188:191], v[148:151], v[96:111]
    s_waitcnt lgkmcnt(0)
    v_mfma_f32_32x32x16_bf16 v[48:63], v[160:163], v[152:155], v[48:63]
    ds_read_b64_tr_b16 v[176:177], v115 offset:28672
    ds_read_b64_tr_b16 v[178:179], v115 offset:29696
    ds_read_b64_tr_b16 v[180:181], v117 offset:28672
    v_mfma_f32_32x32x16_bf16 v[64:79], v[164:167], v[152:155], v[64:79]
    ds_read_b64_tr_b16 v[182:183], v117 offset:29696
    ds_read_b64_tr_b16 v[184:185], v119 offset:28672
    ds_read_b64_tr_b16 v[186:187], v119 offset:29696
    v_mfma_f32_32x32x16_bf16 v[80:95], v[168:171], v[152:155], v[80:95]
    ds_read_b64_tr_b16 v[188:189], v121 offset:28672
    ds_read_b64_tr_b16 v[190:191], v121 offset:29696
    v_mfma_f32_32x32x16_bf16 v[96:111], v[172:175], v[152:155], v[96:111]
    s_waitcnt vmcnt(0) lgkmcnt(0)
    s_barrier
    v_mfma_f32_32x32x16_bf16 v[48:63], v[176:179], v[156:159], v[48:63]
    ds_read_b64_tr_b16 v[160:161], v116 offset:0
    ds_read_b64_tr_b16 v[162:163], v116 offset:1024
    ds_read_b64_tr_b16 v[164:165], v118 offset:0
    v_mfma_f32_32x32x16_bf16 v[64:79], v[180:183], v[156:159], v[64:79]
    ds_read_b64_tr_b16 v[166:167], v118 offset:1024
    ds_read_b64_tr_b16 v[168:169], v120 offset:0
    ds_read_b64_tr_b16 v[170:171], v120 offset:1024
    v_mfma_f32_32x32x16_bf16 v[80:95], v[184:187], v[156:159], v[80:95]
    ds_read_b64_tr_b16 v[172:173], v122 offset:0
    ds_read_b64_tr_b16 v[174:175], v122 offset:1024
    v_mfma_f32_32x32x16_bf16 v[96:111], v[188:191], v[156:159], v[96:111]
    s_waitcnt lgkmcnt(0)
    v_mfma_f32_32x32x16_bf16 v[48:63], v[160:163], v[192:195], v[48:63]
    ds_read_b64_tr_b16 v[176:177], v116 offset:4096
    ds_read_b64_tr_b16 v[178:179], v116 offset:5120
    ds_read_b64_tr_b16 v[180:181], v118 offset:4096
    v_mfma_f32_32x32x16_bf16 v[64:79], v[164:167], v[192:195], v[64:79]
    ds_read_b64_tr_b16 v[182:183], v118 offset:5120
    ds_read_b64_tr_b16 v[184:185], v120 offset:4096
    ds_read_b64_tr_b16 v[186:187], v120 offset:5120
    v_mfma_f32_32x32x16_bf16 v[80:95], v[168:171], v[192:195], v[80:95]
    ds_read_b64_tr_b16 v[188:189], v122 offset:4096
    ds_read_b64_tr_b16 v[190:191], v122 offset:5120
    v_mfma_f32_32x32x16_bf16 v[96:111], v[172:175], v[192:195], v[96:111]
    s_waitcnt lgkmcnt(0)
    v_mfma_f32_32x32x16_bf16 v[48:63], v[176:179], v[196:199], v[48:63]
    ds_read_b64_tr_b16 v[160:161], v116 offset:8192
    ds_read_b64_tr_b16 v[162:163], v116 offset:9216
    ds_read_b64_tr_b16 v[164:165], v118 offset:8192
    v_mfma_f32_32x32x16_bf16 v[64:79], v[180:183], v[196:199], v[64:79]
    ds_read_b64_tr_b16 v[166:167], v118 offset:9216
    ds_read_b64_tr_b16 v[168:169], v120 offset:8192
    ds_read_b64_tr_b16 v[170:171], v120 offset:9216
    v_mfma_f32_32x32x16_bf16 v[80:95], v[184:187], v[196:199], v[80:95]
    ds_read_b64_tr_b16 v[172:173], v122 offset:8192
    ds_read_b64_tr_b16 v[174:175], v122 offset:9216
    v_mfma_f32_32x32x16_bf16 v[96:111], v[188:191], v[196:199], v[96:111]
    s_waitcnt lgkmcnt(0)
    v_mfma_f32_32x32x16_bf16 v[48:63], v[160:163], v[200:203], v[48:63]
    ds_read_b64_tr_b16 v[176:177], v116 offset:12288
    ds_read_b64_tr_b16 v[178:179], v116 offset:13312
    ds_read_b64_tr_b16 v[180:181], v118 offset:12288
    v_mfma_f32_32x32x16_bf16 v[64:79], v[164:167], v[200:203], v[64:79]
    ds_read_b64_tr_b16 v[182:183], v118 offset:13312
    ds_read_b64_tr_b16 v[184:185], v120 offset:12288
    ds_read_b64_tr_b16 v[186:187], v120 offset:13312
    v_mfma_f32_32x32x16_bf16 v[80:95], v[168:171], v[200:203], v[80:95]
    ds_read_b64_tr_b16 v[188:189], v122 offset:12288
    ds_read_b64_tr_b16 v[190:191], v122 offset:13312
    v_mfma_f32_32x32x16_bf16 v[96:111], v[172:175], v[200:203], v[96:111]
    s_waitcnt lgkmcnt(0)
    v_mfma_f32_32x32x16_bf16 v[48:63], v[176:179], v[204:207], v[48:63]
    v_mfma_f32_32x32x16_bf16 v[64:79], v[180:183], v[204:207], v[64:79]
    v_mfma_f32_32x32x16_bf16 v[80:95], v[184:187], v[204:207], v[80:95]
    v_mfma_f32_32x32x16_bf16 v[96:111], v[188:191], v[204:207], v[96:111]
    s_nop 11
    v_cvt_pk_bf16_f32 v16, v48, v49
    v_cvt_pk_bf16_f32 v17, v50, v51
    v_cvt_pk_bf16_f32 v18, v52, v53
    v_cvt_pk_bf16_f32 v19, v54, v55
    v_cvt_pk_bf16_f32 v20, v56, v57
    v_cvt_pk_bf16_f32 v21, v58, v59
    v_cvt_pk_bf16_f32 v22, v60, v61
    v_cvt_pk_bf16_f32 v23, v62, v63
    v_cvt_pk_bf16_f32 v24, v64, v65
    v_cvt_pk_bf16_f32 v25, v66, v67
    v_cvt_pk_bf16_f32 v26, v68, v69
    v_cvt_pk_bf16_f32 v27, v70, v71
    v_cvt_pk_bf16_f32 v28, v72, v73
    v_cvt_pk_bf16_f32 v29, v74, v75
    v_cvt_pk_bf16_f32 v30, v76, v77
    v_cvt_pk_bf16_f32 v31, v78, v79
    v_cvt_pk_bf16_f32 v32, v80, v81
    v_cvt_pk_bf16_f32 v33, v82, v83
    v_cvt_pk_bf16_f32 v34, v84, v85
    v_cvt_pk_bf16_f32 v35, v86, v87
    v_cvt_pk_bf16_f32 v36, v88, v89
    v_cvt_pk_bf16_f32 v37, v90, v91
    v_cvt_pk_bf16_f32 v38, v92, v93
    v_cvt_pk_bf16_f32 v39, v94, v95
    v_cvt_pk_bf16_f32 v40, v96, v97
    v_cvt_pk_bf16_f32 v41, v98, v99
    v_cvt_pk_bf16_f32 v42, v100, v101
    v_cvt_pk_bf16_f32 v43, v102, v103
    v_cvt_pk_bf16_f32 v44, v104, v105
    v_cvt_pk_bf16_f32 v45, v106, v107
    v_cvt_pk_bf16_f32 v46, v108, v109
    v_cvt_pk_bf16_f32 v47, v110, v111
    s_lshl_b32 s48, s3, 13
    s_add_u32 s48, s48, 0x18000
    v_add_u32 v10, s48, v5
    ds_write_b128 v10, v[16:19] offset:0
    ds_write_b128 v10, v[20:23] offset:1024
    ds_write_b128 v10, v[24:27] offset:2048
    ds_write_b128 v10, v[28:31] offset:3072
    ds_write_b128 v10, v[32:35] offset:4096
    ds_write_b128 v10, v[36:39] offset:5120
    ds_write_b128 v10, v[40:43] offset:6144
    ds_write_b128 v10, v[44:47] offset:7168
    s_mov_b32 s52, 0
.Lattn_k_blk_6:
    s_cmp_lg_u32 s52, 0
    s_cbranch_scc1 .Lattn_k_b2_9
    s_waitcnt lgkmcnt(0)
    s_barrier
    s_mov_b32 m0, s45
    s_nop 0
    buffer_load_dwordx4 v6, s[12:15], s43 offen offset:0 lds
    buffer_load_dwordx4 v6, s[12:15], s43 offen offset:1024 lds
    buffer_load_dwordx4 v6, s[12:15], s43 offen offset:2048 lds
    buffer_load_dwordx4 v6, s[12:15], s43 offen offset:3072 lds
    s_add_u32 s43, s43, 0x8000
    s_xor_b32 s45, s45, s88
    s_cmp_eq_u32 s38, 0
    s_cbranch_scc1 .Lattn_k_pj_10
    s_lshl_b32 s48, s39, 13
    s_add_u32 s48, s48, 0x18000
    v_add_u32 v10, s48, v5
    ds_read_b128 v[16:19], v10 offset:0
    ds_read_b128 v[20:23], v10 offset:1024
    ds_read_b128 v[24:27], v10 offset:2048
    ds_read_b128 v[28:31], v10 offset:3072
    ds_read_b128 v[32:35], v10 offset:4096
    ds_read_b128 v[36:39], v10 offset:5120
    ds_read_b128 v[40:43], v10 offset:6144
    ds_read_b128 v[44:47], v10 offset:7168
    s_branch .Lattn_k_pj_10
.Lattn_k_b2_9:
    s_lshl_b32 s48, s39, 12
    s_add_u32 s46, s50, s48
    s_add_u32 s46, s46, 0x8000
    s_mov_b32 s44, s51
    s_mov_b32 m0, s46
    s_nop 0
    buffer_load_dwordx4 v6, s[16:19], s44 offen offset:0 lds
    buffer_load_dwordx4 v6, s[16:19], s44 offen offset:1024 lds
    buffer_load_dwordx4 v6, s[16:19], s44 offen offset:2048 lds
    buffer_load_dwordx4 v6, s[16:19], s44 offen offset:3072 lds
    s_add_u32 s44, s44, 0x8000
    s_xor_b32 s46, s46, s89
    buffer_load_dword v4, v3, s[24:27], 0 offen
    buffer_load_dword v4, v3, s[28:31], 0 offen
    buffer_load_dword v4, v3, s[32:35], 0 offen
.Lattn_k_pj_10:
    v_add_u32 v7, s50, v5
    v_add_u32 v8, 0x8000, v7
    v_xor_b32 v8, s89, v8
    v_mov_b32 v144, 0
    v_mov_b32 v145, 0
    v_mov_b32 v146, 0
    v_mov_b32 v147, 0
    v_mov_b32 v148, 0
    v_mov_b32 v149, 0
    v_mov_b32 v150, 0
    v_mov_b32 v151, 0
    v_mov_b32 v152, 0
    v_mov_b32 v153, 0
    v_mov_b32 v154, 0
    v_mov_b32 v155, 0
    v_mov_b32 v156, 0
    v_mov_b32 v157, 0
    v_mov_b32 v158, 0
    v_mov_b32 v159, 0
    v_mov_b32 v208, 0
    v_mov_b32 v209, 0
    v_mov_b32 v210, 0
    v_mov_b32 v211, 0
    s_mov_b32 s47, 1
    s_mov_b32 s41, 0
    s_cmp_lg_u32 s52, 0
    s_cbranch_scc1 .Lattn_k_npf_11
    s_waitcnt vmcnt(4) lgkmcnt(0)
    s_barrier
.Lattn_k_npf_11:
    s_cmp_eq_u32 s38, 0
    s_cbranch_scc1 .Lattn_k_g0a_12
    s_barrier
.Lattn_k_g0a_12:
    ds_read_b128 v[176:179], v7 offset:0
    ds_read_b128 v[180:183], v7 offset:8192
    ds_read_b128 v[184:187], v7 offset:1024
    ds_read_b128 v[188:191], v7 offset:9216
    ds_read_b128 v[192:195], v7 offset:2048
    ds_read_b128 v[196:199], v7 offset:10240
    ds_read_b128 v[200:203], v7 offset:3072
    s_waitcnt lgkmcnt(6)
    v_mfma_f32_32x32x16_bf16 v[112:127], v[176:179], v[16:19], v[144:159]
    ds_read_b128 v[204:207], v7 offset:11264
    v_mov_b32 v48, 0
    v_mov_b32 v49, 0
    v_mov_b32 v50, 0
    v_mov_b32 v51, 0
    s_waitcnt lgkmcnt(6)
    v_mfma_f32_32x32x16_bf16 v[128:143], v[180:183], v[16:19], v[144:159]
    ds_read_b128 v[176:179], v7 offset:4096
    v_mov_b32 v52, 0
    v_mov_b32 v53, 0
    v_mov_b32 v54, 0
    v_mov_b32 v55, 0
    s_waitcnt lgkmcnt(6)
    v_mfma_f32_32x32x16_bf16 v[112:127], v[184:187], v[20:23], v[112:127]
    ds_read_b128 v[180:183], v7 offset:12288
    v_mov_b32 v56, 0
    v_mov_b32 v57, 0
    v_mov_b32 v58, 0
    v_mov_b32 v59, 0
    s_waitcnt lgkmcnt(6)
    v_mfma_f32_32x32x16_bf16 v[128:143], v[188:191], v[20:23], v[128:143]
    ds_read_b128 v[184:187], v7 offset:5120
    v_mov_b32 v60, 0
    v_mov_b32 v61, 0
    v_mov_b32 v62, 0
    v_mov_b32 v63, 0
    s_waitcnt lgkmcnt(6)
    v_mfma_f32_32x32x16_bf16 v[112:127], v[192:195], v[24:27], v[112:127]
    ds_read_b128 v[188:191], v7 offset:13312
    v_mov_b32 v64, 0
    v_mov_b32 v65, 0
    v_mov_b32 v66, 0
    v_mov_b32 v67, 0
    s_waitcnt lgkmcnt(6)
    v_mfma_f32_32x32x16_bf16 v[128:143], v[196:199], v[24:27], v[128:143]
    ds_read_b128 v[192:195], v7 offset:6144
    v_mov_b32 v68, 0
    v_mov_b32 v69, 0
    v_mov_b32 v70, 0
    v_mov_b32 v71, 0
    s_waitcnt lgkmcnt(6)
    v_mfma_f32_32x32x16_bf16 v[112:127], v[200:203], v[28:31], v[112:127]
    ds_read_b128 v[196:199], v7 offset:14336
    v_mov_b32 v72, 0
    v_mov_b32 v73, 0
    v_mov_b32 v74, 0
    v_mov_b32 v75, 0
    s_waitcnt lgkmcnt(6)
    v_mfma_f32_32x32x16_bf16 v[128:143], v[204:207], v[28:31], v[128:143]
    ds_read_b128 v[200:203], v7 offset:7168
    v_mov_b32 v76, 0
    v_mov_b32 v77, 0
    v_mov_b32 v78, 0
    v_mov_b32 v79, 0
    s_waitcnt lgkmcnt(6)
    v_mfma_f32_32x32x16_bf16 v[112:127], v[176:179], v[32:35], v[112:127]
    ds_read_b128 v[204:207], v7 offset:15360
    v_mov_b32 v80, 0
    v_mov_b32 v81, 0
    v_mov_b32 v82, 0
    v_mov_b32 v83, 0
    s_waitcnt lgkmcnt(6)
    v_mfma_f32_32x32x16_bf16 v[128:143], v[180:183], v[32:35], v[128:143]
    v_mov_b32 v84, 0
    v_mov_b32 v85, 0
    v_mov_b32 v86, 0
    v_mov_b32 v87, 0
    s_waitcnt lgkmcnt(5)
    v_mfma_f32_32x32x16_bf16 v[112:127], v[184:187], v[36:39], v[112:127]
    v_mov_b32 v88, 0
    v_mov_b32 v89, 0
    v_mov_b32 v90, 0
    v_mov_b32 v91, 0
    s_waitcnt lgkmcnt(4)
    v_mfma_f32_32x32x16_bf16 v[128:143], v[188:191], v[36:39], v[128:143]
    v_mov_b32 v92, 0
    v_mov_b32 v93, 0
    v_mov_b32 v94, 0
    v_mov_b32 v95, 0
    s_waitcnt lgkmcnt(3)
    v_mfma_f32_32x32x16_bf16 v[112:127], v[192:195], v[40:43], v[112:127]
    v_mov_b32 v96, 0
    v_mov_b32 v97, 0
    v_mov_b32 v98, 0
    v_mov_b32 v99, 0
    s_waitcnt lgkmcnt(2)
    v_mfma_f32_32x32x16_bf16 v[128:143], v[196:199], v[40:43], v[128:143]
    v_mov_b32 v100, 0
    v_mov_b32 v101, 0
    v_mov_b32 v102, 0
    v_mov_b32 v103, 0
    s_waitcnt lgkmcnt(1)
    v_mfma_f32_32x32x16_bf16 v[112:127], v[200:203], v[44:47], v[112:127]
    v_mov_b32 v104, 0
    v_mov_b32 v105, 0
    v_mov_b32 v106, 0
    v_mov_b32 v107, 0
    s_waitcnt lgkmcnt(0)
    v_mfma_f32_32x32x16_bf16 v[128:143], v[204:207], v[44:47], v[128:143]
    v_mov_b32 v108, 0
    v_mov_b32 v109, 0
    v_mov_b32 v110, 0
    v_mov_b32 v111, 0
    s_cmp_eq_u32 s52, 0
    s_cbranch_scc1 .Lattn_k_w0_13
    s_waitcnt vmcnt(3)
    s_branch .Lattn_k_w1_14
.Lattn_k_w0_13:
    s_waitcnt vmcnt(0)
.Lattn_k_w1_14:
    s_barrier
    s_cmp_eq_u32 s42, 0
    s_cbranch_scc1 .Lattn_k_last_8
.Lattn_k_loop_7:
    s_setprio 0
    v_xor_b32 v7, s88, v7
    v_xor_b32 v8, s89, v8
    s_add_u32 s48, s41, 2
    s_cmp_gt_u32 s48, s42
    s_cselect_b32 s14, 0, 0x1000000
    ds_read_b128 v[176:179], v8 offset:0
    ds_read_b128 v[180:183], v8 offset:1024
    ds_read_b128 v[184:187], v8 offset:2048
    ds_read_b128 v[188:191], v8 offset:3072
    ds_read_b128 v[192:195], v8 offset:4096
    ds_read_b128 v[196:199], v8 offset:5120
    ds_read_b128 v[200:203], v8 offset:6144
    s_mov_b32 m0, s45
    s_nop 0
    buffer_load_dwordx4 v6, s[12:15], s43 offen offset:0 lds
    v_max3_f32 v212, v112, v113, v114
    v_max3_f32 v213, v128, v129, v130
    v_max3_f32 v212, v212, v115, v116
    v_max3_f32 v213, v213, v131, v132
    v_max3_f32 v212, v212, v117, v118
    v_max3_f32 v213, v213, v133, v134
    v_max3_f32 v212, v212, v119, v120
    v_max3_f32 v213, v213, v135, v136
    v_max3_f32 v212, v212, v121, v122
    v_max3_f32 v213, v213, v137, v138
    v_max3_f32 v212, v212, v123, v124
    v_max3_f32 v213, v213, v139, v140
    v_max3_f32 v212, v212, v125, v126
    v_max3_f32 v213, v213, v141, v142
    v_max3_f32 v212, v212, v127, v143
    buffer_load_dwordx4 v6, s[12:15], s43 offen offset:1024 lds
    v_max_f32 v212, v212, v213
    v_cmp_lt_f32 vcc, 0x41c00000, v212
    s_cmp_lg_u32 s47, 0
    s_cbranch_scc1 .Lattn_k_slow_2
    s_cbranch_vccnz .Lattn_k_slow_2
.Lattn_k_back_3:
    v_exp_f32 v112, v112
    v_exp_f32 v113, v113
    v_exp_f32 v114, v114
    v_exp_f32 v115, v115
    v_add_f32 v210, v210, v112
    v_add_f32 v211, v211, v113
    v_cvt_pk_bf16_f32 v160, v112, v113
    v_exp_f32 v116, v116
    buffer_load_dwordx4 v6, s[12:15], s43 offen offset:2048 lds
    v_exp_f32 v117, v117
    v_add_f32 v208, v208, v114
    v_add_f32 v209, v209, v115
    v_cvt_pk_bf16_f32 v161, v114, v115
    v_exp_f32 v118, v118
    v_exp_f32 v119, v119
    v_add_f32 v210, v210, v116
    v_add_f32 v211, v211, v117
    v_cvt_pk_bf16_f32 v162, v116, v117
    v_exp_f32 v120, v120
    v_exp_f32 v121, v121
    buffer_load_dwordx4 v6, s[12:15], s43 offen offset:3072 lds
    v_add_f32 v208, v208, v118
    v_add_f32 v209, v209, v119
    v_cvt_pk_bf16_f32 v163, v118, v119
    v_exp_f32 v122, v122
    v_exp_f32 v123, v123
    v_add_f32 v210, v210, v120
    v_add_f32 v211, v211, v121
    v_cvt_pk_bf16_f32 v164, v120, v121
    v_exp_f32 v124, v124
    v_exp_f32 v125, v125
    s_mov_b32 m0, s46
    s_nop 0
    buffer_load_dwordx4 v6, s[16:19], s44 offen offset:0 lds
    v_add_f32 v208, v208, v122
    v_add_f32 v209, v209, v123
    v_cvt_pk_bf16_f32 v165, v122, v123
    v_exp_f32 v126, v126
    v_exp_f32 v127, v127
    v_add_f32 v210, v210, v124
    v_add_f32 v211, v211, v125
    v_cvt_pk_bf16_f32 v166, v124, v125
    v_exp_f32 v128, v128
    v_exp_f32 v129, v129
    buffer_load_dwordx4 v6, s[16:19], s44 offen offset:1024 lds
    v_add_f32 v208, v208, v126
    v_add_f32 v209, v209, v127
    v_cvt_pk_bf16_f32 v167, v126, v127
    v_exp_f32 v130, v130
    v_exp_f32 v131, v131
    v_add_f32 v210, v210, v128
    v_add_f32 v211, v211, v129
    v_cvt_pk_bf16_f32 v168, v128, v129
    v_exp_f32 v132, v132
    v_exp_f32 v133, v133
    buffer_load_dwordx4 v6, s[16:19], s44 offen offset:2048 lds
    v_add_f32 v208, v208, v130
    v_add_f32 v209, v209, v131
    v_cvt_pk_bf16_f32 v169, v130, v131
    v_exp_f32 v134, v134
    v_exp_f32 v135, v135
    v_add_f32 v210, v210, v132
    v_add_f32 v211, v211, v133
    v_cvt_pk_bf16_f32 v170, v132, v133
    v_exp_f32 v136, v136
    v_exp_f32 v137, v137
    buffer_load_dwordx4 v6, s[16:19], s44 offen offset:3072 lds
    s_add_u32 s43, s43, 0x8000
    s_add_u32 s44, s44, 0x8000
    s_xor_b32 s45, s45, s88
    s_xor_b32 s46, s46, s89
    v_add_f32 v208, v208, v134
    v_add_f32 v209, v209, v135
    v_cvt_pk_bf16_f32 v171, v134, v135
    v_exp_f32 v138, v138
    v_exp_f32 v139, v139
    v_add_f32 v210, v210, v136
    v_add_f32 v211, v211, v137
    v_cvt_pk_bf16_f32 v172, v136, v137
    v_exp_f32 v140, v140
    v_exp_f32 v141, v141
    v_add_f32 v208, v208, v138
    v_add_f32 v209, v209, v139
    v_cvt_pk_bf16_f32 v173, v138, v139
    v_exp_f32 v142, v142
    v_exp_f32 v143, v143
    v_add_f32 v210, v210, v140
    v_add_f32 v211, v211, v141
    v_cvt_pk_bf16_f32 v174, v140, v141
    s_nop 0
    v_add_f32 v208, v208, v142
    v_add_f32 v209, v209, v143
    v_cvt_pk_bf16_f32 v175, v142, v143
    s_barrier
    s_setprio 1
    s_waitcnt lgkmcnt(6)
    v_mfma_f32_32x32x16_bf16 v[48:63], v[176:179], v[160:163], v[48:63]
    ds_read_b128 v[204:207], v8 offset:7168
    s_waitcnt lgkmcnt(6)
    v_mfma_f32_32x32x16_bf16 v[64:79], v[180:183], v[160:163], v[64:79]
    ds_read_b128 v[176:179], v8 offset:8192
    s_waitcnt lgkmcnt(6)
    v_mfma_f32_32x32x16_bf16 v[80:95], v[184:187], v[160:163], v[80:95]
    ds_read_b128 v[180:183], v8 offset:9216
    s_waitcnt lgkmcnt(6)
    v_mfma_f32_32x32x16_bf16 v[96:111], v[188:191], v[160:163], v[96:111]
    ds_read_b128 v[184:187], v8 offset:10240
    s_waitcnt lgkmcnt(6)
    v_mfma_f32_32x32x16_bf16 v[48:63], v[192:195], v[164:167], v[48:63]
    ds_read_b128 v[188:191], v8 offset:11264
    s_waitcnt lgkmcnt(6)
    v_mfma_f32_32x32x16_bf16 v[64:79], v[196:199], v[164:167], v[64:79]
    ds_read_b128 v[192:195], v8 offset:12288
    s_waitcnt lgkmcnt(6)
    v_mfma_f32_32x32x16_bf16 v[80:95], v[200:203], v[164:167], v[80:95]
    ds_read_b128 v[196:199], v8 offset:13312
    s_waitcnt lgkmcnt(6)
    v_mfma_f32_32x32x16_bf16 v[96:111], v[204:207], v[164:167], v[96:111]
    ds_read_b128 v[200:203], v8 offset:14336
    s_waitcnt lgkmcnt(6)
    v_mfma_f32_32x32x16_bf16 v[48:63], v[176:179], v[168:171], v[48:63]
    ds_read_b128 v[204:207], v8 offset:15360
    s_waitcnt lgkmcnt(6)
    v_mfma_f32_32x32x16_bf16 v[64:79], v[180:183], v[168:171], v[64:79]
    ds_read_b128 v[176:179], v7 offset:0
    s_waitcnt lgkmcnt(6)
    v_mfma_f32_32x32x16_bf16 v[80:95], v[184:187], v[168:171], v[80:95]
    ds_read_b128 v[180:183], v7 offset:8192
    s_waitcnt lgkmcnt(6)
    v_mfma_f32_32x32x16_bf16 v[96:111], v[188:191], v[168:171], v[96:111]
    ds_read_b128 v[184:187], v7 offset:1024
    s_waitcnt lgkmcnt(6)
    v_mfma_f32_32x32x16_bf16 v[48:63], v[192:195], v[172:175], v[48:63]
    ds_read_b128 v[188:191], v7 offset:9216
    s_waitcnt lgkmcnt(6)
    v_mfma_f32_32x32x16_bf16 v[64:79], v[196:199], v[172:175], v[64:79]
    ds_read_b128 v[192:195], v7 offset:2048
    s_waitcnt lgkmcnt(6)
    v_mfma_f32_32x32x16_bf16 v[80:95], v[200:203], v[172:175], v[80:95]
    ds_read_b128 v[196:199], v7 offset:10240
    s_waitcnt lgkmcnt(6)
    v_mfma_f32_32x32x16_bf16 v[96:111], v[204:207], v[172:175], v[96:111]
    ds_read_b128 v[200:203], v7 offset:3072
    s_waitcnt lgkmcnt(6)
    v_mfma_f32_32x32x16_bf16 v[112:127], v[176:179], v[16:19], v[144:159]
    ds_read_b128 v[204:207], v7 offset:11264
    s_waitcnt lgkmcnt(6)
    v_mfma_f32_32x32x16_bf16 v[128:143], v[180:183], v[16:19], v[144:159]
    ds_read_b128 v[176:179], v7 offset:4096
    s_waitcnt lgkmcnt(6)
    v_mfma_f32_32x32x16_bf16 v[112:127], v[184:187], v[20:23], v[112:127]
    ds_read_b128 v[180:183], v7 offset:12288
    s_waitcnt lgkmcnt(6)
    v_mfma_f32_32x32x16_bf16 v[128:143], v[188:191], v[20:23], v[128:143]
    ds_read_b128 v[184:187], v7 offset:5120
    s_waitcnt lgkmcnt(6)
    v_mfma_f32_32x32x16_bf16 v[112:127], v[192:195], v[24:27], v[112:127]
    ds_read_b128 v[188:191], v7 offset:13312
    s_waitcnt lgkmcnt(6)
    v_mfma_f32_32x32x16_bf16 v[128:143], v[196:199], v[24:27], v[128:143]
    ds_read_b128 v[192:195], v7 offset:6144
    s_waitcnt lgkmcnt(6)
    v_mfma_f32_32x32x16_bf16 v[112:127], v[200:203], v[28:31], v[112:127]
    ds_read_b128 v[196:199], v7 offset:14336
    s_waitcnt lgkmcnt(6)
    v_mfma_f32_32x32x16_bf16 v[128:143], v[204:207], v[28:31], v[128:143]
    ds_read_b128 v[200:203], v7 offset:7168
    s_waitcnt lgkmcnt(6)
    v_mfma_f32_32x32x16_bf16 v[112:127], v[176:179], v[32:35], v[112:127]
    ds_read_b128 v[204:207], v7 offset:15360
    s_waitcnt lgkmcnt(6)
    v_mfma_f32_32x32x16_bf16 v[128:143], v[180:183], v[32:35], v[128:143]
    s_waitcnt lgkmcnt(5)
    v_mfma_f32_32x32x16_bf16 v[112:127], v[184:187], v[36:39], v[112:127]
    s_waitcnt lgkmcnt(4)
    v_mfma_f32_32x32x16_bf16 v[128:143], v[188:191], v[36:39], v[128:143]
    s_waitcnt lgkmcnt(3)
    v_mfma_f32_32x32x16_bf16 v[112:127], v[192:195], v[40:43], v[112:127]
    s_waitcnt lgkmcnt(2)
    v_mfma_f32_32x32x16_bf16 v[128:143], v[196:199], v[40:43], v[128:143]
    s_waitcnt lgkmcnt(1)
    v_mfma_f32_32x32x16_bf16 v[112:127], v[200:203], v[44:47], v[112:127]
    s_waitcnt lgkmcnt(0)
    v_mfma_f32_32x32x16_bf16 v[128:143], v[204:207], v[44:47], v[128:143]
    s_waitcnt vmcnt(0)
    s_barrier
    s_add_u32 s41, s41, 1
    s_cmp_lt_u32 s41, s42
    s_cbranch_scc1 .Lattn_k_loop_7
.Lattn_k_last_8:
    s_setprio 0
    s_lshl_b32 s48, s39, 12
    s_add_u32 s45, s50, s48
    s_mov_b32 s43, s51
    s_cmp_eq_u32 s52, 0
    s_cselect_b32 s14, 0x1000000, 0
    s_cbranch_scc0 .Lattn_k_noq_17
    s_lshl_b32 s48, s39, 13
    s_add_u32 s48, s48, 0x20000
    v_add_u32 v10, s48, v5
    ds_read_b128 v[16:19], v10 offset:0
    ds_read_b128 v[20:23], v10 offset:1024
    ds_read_b128 v[24:27], v10 offset:2048
    ds_read_b128 v[28:31], v10 offset:3072
    ds_read_b128 v[32:35], v10 offset:4096
    ds_read_b128 v[36:39], v10 offset:5120
    ds_read_b128 v[40:43], v10 offset:6144
    ds_read_b128 v[44:47], v10 offset:7168
.Lattn_k_noq_17:
    s_cmp_lg_u32 s49, 0
    s_cbranch_scc1 .Lattn_k_skipl_15
    v_xor_b32 v7, s88, v7
    v_xor_b32 v8, s89, v8
    ds_read_b128 v[176:179], v8 offset:0
    ds_read_b128 v[180:183], v8 offset:1024
    ds_read_b128 v[184:187], v8 offset:2048
    ds_read_b128 v[188:191], v8 offset:3072
    ds_read_b128 v[192:195], v8 offset:4096
    ds_read_b128 v[196:199], v8 offset:5120
    ds_read_b128 v[200:203], v8 offset:6144
    v_cmp_lt_i32 s[54:55], v9, 0
    v_cmp_lt_i32 s[56:57], v9, 1
    v_cmp_lt_i32 s[58:59], v9, 2
    v_cmp_lt_i32 s[60:61], v9, 3
    s_nop 1
    v_cndmask_b32 v112, v112, v14, s[54:55]
    v_cndmask_b32 v113, v113, v14, s[56:57]
    v_cndmask_b32 v114, v114, v14, s[58:59]
    v_cndmask_b32 v115, v115, v14, s[60:61]
    v_cmp_lt_i32 s[54:55], v9, 8
    v_cmp_lt_i32 s[56:57], v9, 9
    v_cmp_lt_i32 s[58:59], v9, 10
    v_cmp_lt_i32 s[60:61], v9, 11
    s_nop 1
    v_cndmask_b32 v116, v116, v14, s[54:55]
    v_cndmask_b32 v117, v117, v14, s[56:57]
    v_cndmask_b32 v118, v118, v14, s[58:59]
    v_cndmask_b32 v119, v119, v14, s[60:61]
    v_cmp_lt_i32 s[54:55], v9, 16
    v_cmp_lt_i32 s[56:57], v9, 17
    v_cmp_lt_i32 s[58:59], v9, 18
    v_cmp_lt_i32 s[60:61], v9, 19
    s_nop 1
    v_cndmask_b32 v120, v120, v14, s[54:55]
    v_cndmask_b32 v121, v121, v14, s[56:57]
    v_cndmask_b32 v122, v122, v14, s[58:59]
    v_cndmask_b32 v123, v123, v14, s[60:61]
    v_cmp_lt_i32 s[54:55], v9, 24
    v_cmp_lt_i32 s[56:57], v9, 25
    v_cmp_lt_i32 s[58:59], v9, 26
    v_cmp_lt_i32 s[60:61], v9, 27
    s_nop 1
    v_cndmask_b32 v124, v124, v14, s[54:55]
    v_cndmask_b32 v125, v125, v14, s[56:57]
    v_cndmask_b32 v126, v126, v14, s[58:59]
    v_cndmask_b32 v127, v127, v14, s[60:61]
    v_cmp_lt_i32 s[54:55], v9, 32
    v_cmp_lt_i32 s[56:57], v9, 33
    v_cmp_lt_i32 s[58:59], v9, 34
    v_cmp_lt_i32 s[60:61], v9, 35
    s_nop 1
    v_cndmask_b32 v128, v128, v14, s[54:55]
    v_cndmask_b32 v129, v129, v14, s[56:57]
    v_cndmask_b32 v130, v130, v14, s[58:59]
    v_cndmask_b32 v131, v131, v14, s[60:61]
    v_cmp_lt_i32 s[54:55], v9, 40
    v_cmp_lt_i32 s[56:57], v9, 41
    v_cmp_lt_i32 s[58:59], v9, 42
    v_cmp_lt_i32 s[60:61], v9, 43
    s_nop 1
    v_cndmask_b32 v132, v132, v14, s[54:55]
    v_cndmask_b32 v133, v133, v14, s[56:57]
    v_cndmask_b32 v134, v134, v14, s[58:59]
    v_cndmask_b32 v135, v135, v14, s[60:61]
    v_cmp_lt_i32 s[54:55], v9, 48
    v_cmp_lt_i32 s[56:57], v9, 49
    v_cmp_lt_i32 s[58:59], v9, 50
    v_cmp_lt_i32 s[60:61], v9, 51
    s_nop 1
    v_cndmask_b32 v136, v136, v14, s[54:55]
    v_cndmask_b32 v137, v137, v14, s[56:57]
    v_cndmask_b32 v138, v138, v14, s[58:59]
    v_cndmask_b32 v139, v139, v14, s[60:61]
    v_cmp_lt_i32 s[54:55], v9, 56
    v_cmp_lt_i32 s[56:57], v9, 57
    v_cmp_lt_i32 s[58:59], v9, 58
    v_cmp_lt_i32 s[60:61], v9, 59
    s_nop 1
    v_cndmask_b32 v140, v140, v14, s[54:55]
    v_cndmask_b32 v141, v141, v14, s[56:57]
    v_cndmask_b32 v142, v142, v14, s[58:59]
    v_cndmask_b32 v143, v143, v14, s[60:61]
    s_mov_b32 m0, s45
    s_nop 0
    buffer_load_dwordx4 v6, s[12:15], s43 offen offset:0 lds
    v_max3_f32 v212, v112, v113, v114
    v_max3_f32 v213, v128, v129, v130
    v_max3_f32 v212, v212, v115, v116
    v_max3_f32 v213, v213, v131, v132
    v_max3_f32 v212, v212, v117, v118
    v_max3_f32 v213, v213, v133, v134
    v_max3_f32 v212, v212, v119, v120
    v_max3_f32 v213, v213, v135, v136
    v_max3_f32 v212, v212, v121, v122
    v_max3_f32 v213, v213, v137, v138
    v_max3_f32 v212, v212, v123, v124
    v_max3_f32 v213, v213, v139, v140
    v_max3_f32 v212, v212, v125, v126
    v_max3_f32 v213, v213, v141, v142
    v_max3_f32 v212, v212, v127, v143
    buffer_load_dwordx4 v6, s[12:15], s43 offen offset:1024 lds
    v_max_f32 v212, v212, v213
    v_cmp_lt_f32 vcc, 0x41c00000, v212
    s_cmp_lg_u32 s47, 0
    s_cbranch_scc1 .Lattn_k_slow_4
    s_cbranch_vccnz .Lattn_k_slow_4
.Lattn_k_back_5:
    v_exp_f32 v112, v112
    v_exp_f32 v113, v113
    v_exp_f32 v114, v114
    v_exp_f32 v115, v115
    v_add_f32 v210, v210, v112
    v_add_f32 v211, v211, v113
    v_cvt_pk_bf16_f32 v160, v112, v113
    v_exp_f32 v116, v116
    buffer_load_dwordx4 v6, s[12:15], s43 offen offset:2048 lds
    v_exp_f32 v117, v117
    v_add_f32 v208, v208, v114
    v_add_f32 v209, v209, v115
    v_cvt_pk_bf16_f32 v161, v114, v115
    v_exp_f32 v118, v118
    v_exp_f32 v119, v119
    v_add_f32 v210, v210, v116
    v_add_f32 v211, v211, v117
    v_cvt_pk_bf16_f32 v162, v116, v117
    v_exp_f32 v120, v120
    v_exp_f32 v121, v121
    buffer_load_dwordx4 v6, s[12:15], s43 offen offset:3072 lds
    s_add_u32 s43, s43, 0x8000
    s_xor_b32 s45, s45, s88
    v_add_f32 v208, v208, v118
    v_add_f32 v209, v209, v119
    v_cvt_pk_bf16_f32 v163, v118, v119
    v_exp_f32 v122, v122
    v_exp_f32 v123, v123
    v_add_f32 v210, v210, v120
    v_add_f32 v211, v211, v121
    v_cvt_pk_bf16_f32 v164, v120, v121
    v_exp_f32 v124, v124
    v_exp_f32 v125, v125
    s_mov_b32 m0, s45
    s_nop 0
    buffer_load_dwordx4 v6, s[12:15], s43 offen offset:0 lds
    v_add_f32 v208, v208, v122
    v_add_f32 v209, v209, v123
    v_cvt_pk_bf16_f32 v165, v122, v123
    v_exp_f32 v126, v126
    v_exp_f32 v127, v127
    v_add_f32 v210, v210, v124
    v_add_f32 v211, v211, v125
    v_cvt_pk_bf16_f32 v166, v124, v125
    v_exp_f32 v128, v128
    v_exp_f32 v129, v129
    buffer_load_dwordx4 v6, s[12:15], s43 offen offset:1024 lds
    v_add_f32 v208, v208, v126
    v_add_f32 v209, v209, v127
    v_cvt_pk_bf16_f32 v167, v126, v127
    v_exp_f32 v130, v130
    v_exp_f32 v131, v131
    v_add_f32 v210, v210, v128
    v_add_f32 v211, v211, v129
    v_cvt_pk_bf16_f32 v168, v128, v129
    v_exp_f32 v132, v132
    v_exp_f32 v133, v133
    buffer_load_dwordx4 v6, s[12:15], s43 offen offset:2048 lds
    v_add_f32 v208, v208, v130
    v_add_f32 v209, v209, v131
    v_cvt_pk_bf16_f32 v169, v130, v131
    v_exp_f32 v134, v134
    v_exp_f32 v135, v135
    v_add_f32 v210, v210, v132
    v_add_f32 v211, v211, v133
    v_cvt_pk_bf16_f32 v170, v132, v133
    v_exp_f32 v136, v136
    v_exp_f32 v137, v137
    buffer_load_dwordx4 v6, s[12:15], s43 offen offset:3072 lds
    s_add_u32 s43, s43, 0x8000
    s_xor_b32 s45, s45, s88
    v_add_f32 v208, v208, v134
    v_add_f32 v209, v209, v135
    v_cvt_pk_bf16_f32 v171, v134, v135
    v_exp_f32 v138, v138
    v_exp_f32 v139, v139
    v_add_f32 v210, v210, v136
    v_add_f32 v211, v211, v137
    v_cvt_pk_bf16_f32 v172, v136, v137
    v_exp_f32 v140, v140
    v_exp_f32 v141, v141
    v_add_f32 v208, v208, v138
    v_add_f32 v209, v209, v139
    v_cvt_pk_bf16_f32 v173, v138, v139
    v_exp_f32 v142, v142
    v_exp_f32 v143, v143
    v_add_f32 v210, v210, v140
    v_add_f32 v211, v211, v141
    v_cvt_pk_bf16_f32 v174, v140, v141
    s_nop 0
    v_add_f32 v208, v208, v142
    v_add_f32 v209, v209, v143
    v_cvt_pk_bf16_f32 v175, v142, v143
    s_barrier
    s_waitcnt lgkmcnt(6)
    v_mfma_f32_32x32x16_bf16 v[48:63], v[176:179], v[160:163], v[48:63]
    ds_read_b128 v[204:207], v8 offset:7168
    s_waitcnt lgkmcnt(6)
    v_mfma_f32_32x32x16_bf16 v[64:79], v[180:183], v[160:163], v[64:79]
    ds_read_b128 v[176:179], v8 offset:8192
    s_waitcnt lgkmcnt(6)
    v_mfma_f32_32x32x16_bf16 v[80:95], v[184:187], v[160:163], v[80:95]
    ds_read_b128 v[180:183], v8 offset:9216
    s_waitcnt lgkmcnt(6)
    v_mfma_f32_32x32x16_bf16 v[96:111], v[188:191], v[160:163], v[96:111]
    ds_read_b128 v[184:187], v8 offset:10240
    s_waitcnt lgkmcnt(6)
    v_mfma_f32_32x32x16_bf16 v[48:63], v[192:195], v[164:167], v[48:63]
    ds_read_b128 v[188:191], v8 offset:11264
    s_waitcnt lgkmcnt(6)
    v_mfma_f32_32x32x16_bf16 v[64:79], v[196:199], v[164:167], v[64:79]
    ds_read_b128 v[192:195], v8 offset:12288
    s_waitcnt lgkmcnt(6)
    v_mfma_f32_32x32x16_bf16 v[80:95], v[200:203], v[164:167], v[80:95]
    ds_read_b128 v[196:199], v8 offset:13312
    s_waitcnt lgkmcnt(6)
    v_mfma_f32_32x32x16_bf16 v[96:111], v[204:207], v[164:167], v[96:111]
    ds_read_b128 v[200:203], v8 offset:14336
    s_waitcnt lgkmcnt(6)
    v_mfma_f32_32x32x16_bf16 v[48:63], v[176:179], v[168:171], v[48:63]
    ds_read_b128 v[204:207], v8 offset:15360
    s_waitcnt lgkmcnt(6)
    v_mfma_f32_32x32x16_bf16 v[64:79], v[180:183], v[168:171], v[64:79]
    s_waitcnt lgkmcnt(5)
    v_mfma_f32_32x32x16_bf16 v[80:95], v[184:187], v[168:171], v[80:95]
    s_waitcnt lgkmcnt(4)
    v_mfma_f32_32x32x16_bf16 v[96:111], v[188:191], v[168:171], v[96:111]
    s_waitcnt lgkmcnt(3)
    v_mfma_f32_32x32x16_bf16 v[48:63], v[192:195], v[172:175], v[48:63]
    s_waitcnt lgkmcnt(2)
    v_mfma_f32_32x32x16_bf16 v[64:79], v[196:199], v[172:175], v[64:79]
    s_waitcnt lgkmcnt(1)
    v_mfma_f32_32x32x16_bf16 v[80:95], v[200:203], v[172:175], v[80:95]
    s_waitcnt lgkmcnt(0)
    v_mfma_f32_32x32x16_bf16 v[96:111], v[204:207], v[172:175], v[96:111]
    s_waitcnt vmcnt(0)
    s_barrier
    s_branch .Lattn_k_skip2_16
.Lattn_k_skipl_15:
    s_mov_b32 m0, s45
    s_nop 0
    buffer_load_dwordx4 v6, s[12:15], s43 offen offset:0 lds
    buffer_load_dwordx4 v6, s[12:15], s43 offen offset:1024 lds
    buffer_load_dwordx4 v6, s[12:15], s43 offen offset:2048 lds
    buffer_load_dwordx4 v6, s[12:15], s43 offen offset:3072 lds
    s_add_u32 s43, s43, 0x8000
    s_xor_b32 s45, s45, s88
    s_mov_b32 m0, s45
    s_nop 0
    buffer_load_dwordx4 v6, s[12:15], s43 offen offset:0 lds
    buffer_load_dwordx4 v6, s[12:15], s43 offen offset:1024 lds
    buffer_load_dwordx4 v6, s[12:15], s43 offen offset:2048 lds
    buffer_load_dwordx4 v6, s[12:15], s43 offen offset:3072 lds
    s_add_u32 s43, s43, 0x8000
    s_xor_b32 s45, s45, s88
    s_barrier
    s_waitcnt vmcnt(0) lgkmcnt(0)
    s_barrier
.Lattn_k_skip2_16:
    s_cmp_eq_u32 s38, 1
    s_cbranch_scc1 .Lattn_k_g1a_18
    s_barrier
.Lattn_k_g1a_18:
    v_add_f32 v208, v208, v209
    v_add_f32 v210, v210, v211
    v_add_f32 v208, v208, v210
    v_mov_b32 v10, v208
    s_nop 1
    v_permlane32_swap_b32 v208, v10
    s_nop 1
    v_add_f32 v213, v208, v10
    v_sub_f32 v212, 0, v144
    v_mov_b32 v10, 0xf149f2ca
    s_cmp_lg_u32 s47, 0
    s_cselect_b64 vcc, -1, 0
    v_cndmask_b32 v212, v212, v10, vcc
    s_lshl_b32 s48, s3, 13
    s_add_u32 s48, s48, 0x18000
    v_add_u32 v11, s48, v5
    s_xor_b32 s53, s3, 4
    s_lshl_b32 s53, s53, 13
    s_add_u32 s53, s53, 0x18000
    v_add_u32 v12, s53, v5
    s_lshl_b32 s48, s3, 9
    s_add_u32 s48, s48, 0x8000
    v_lshlrev_b32 v13, 3, v1
    v_add_u32 v10, s48, v13
    ds_write_b64 v10, v[212:213]
    s_xor_b32 s48, s48, 0x800
    v_add_u32 v13, s48, v13
    s_cmp_eq_u32 s38, 1
    s_cbranch_scc1 .Lattn_k_mg1_19
    ds_write_b128 v11, v[80:83] offset:0
    ds_write_b128 v11, v[84:87] offset:1024
    ds_write_b128 v11, v[88:91] offset:2048
    ds_write_b128 v11, v[92:95] offset:3072
    ds_write_b128 v11, v[96:99] offset:4096
    ds_write_b128 v11, v[100:103] offset:5120
    ds_write_b128 v11, v[104:107] offset:6144
    ds_write_b128 v11, v[108:111] offset:7168
    s_waitcnt lgkmcnt(0)
    s_barrier
    ds_read_b64 v[208:209], v13
    ds_read_b128 v[112:115], v12 offset:0
    ds_read_b128 v[116:119], v12 offset:1024
    ds_read_b128 v[120:123], v12 offset:2048
    ds_read_b128 v[124:127], v12 offset:3072
    ds_read_b128 v[128:131], v12 offset:4096
    ds_read_b128 v[132:135], v12 offset:5120
    ds_read_b128 v[136:139], v12 offset:6144
    ds_read_b128 v[140:143], v12 offset:7168
    s_waitcnt lgkmcnt(8)
    v_max_f32 v10, v212, v208
    v_sub_f32 v212, v212, v10
    v_sub_f32 v208, v208, v10
    v_exp_f32 v212, v212
    v_exp_f32 v208, v208
    s_nop 0
    v_mul_f32 v10, v212, v213
    v_fmac_f32 v10, v208, v209
    v_rcp_f32 v10, v10
    s_nop 0
    v_mul_f32 v212, v212, v10
    v_mul_f32 v208, v208, v10
    s_waitcnt lgkmcnt(0)
    v_mul_f32 v48, v48, v212
    v_fmac_f32 v48, v112, v208
    v_mul_f32 v49, v49, v212
    v_fmac_f32 v49, v113, v208
    v_mul_f32 v50, v50, v212
    v_fmac_f32 v50, v114, v208
    v_mul_f32 v51, v51, v212
    v_fmac_f32 v51, v115, v208
    v_mul_f32 v52, v52, v212
    v_fmac_f32 v52, v116, v208
    v_mul_f32 v53, v53, v212
    v_fmac_f32 v53, v117, v208
    v_mul_f32 v54, v54, v212
    v_fmac_f32 v54, v118, v208
    v_mul_f32 v55, v55, v212
    v_fmac_f32 v55, v119, v208
    v_mul_f32 v56, v56, v212
    v_fmac_f32 v56, v120, v208
    v_mul_f32 v57, v57, v212
    v_fmac_f32 v57, v121, v208
    v_mul_f32 v58, v58, v212
    v_fmac_f32 v58, v122, v208
    v_mul_f32 v59, v59, v212
    v_fmac_f32 v59, v123, v208
    v_mul_f32 v60, v60, v212
    v_fmac_f32 v60, v124, v208
    v_mul_f32 v61, v61, v212
    v_fmac_f32 v61, v125, v208
    v_mul_f32 v62, v62, v212
    v_fmac_f32 v62, v126, v208
    v_mul_f32 v63, v63, v212
    v_fmac_f32 v63, v127, v208
    v_mul_f32 v64, v64, v212
    v_fmac_f32 v64, v128, v208
    v_mul_f32 v65, v65, v212
    v_fmac_f32 v65, v129, v208
    v_mul_f32 v66, v66, v212
    v_fmac_f32 v66, v130, v208
    v_mul_f32 v67, v67, v212
    v_fmac_f32 v67, v131, v208
    v_mul_f32 v68, v68, v212
    v_fmac_f32 v68, v132, v208
    v_mul_f32 v69, v69, v212
    v_fmac_f32 v69, v133, v208
    v_mul_f32 v70, v70, v212
    v_fmac_f32 v70, v134, v208
    v_mul_f32 v71, v71, v212
    v_fmac_f32 v71, v135, v208
    v_mul_f32 v72, v72, v212
    v_fmac_f32 v72, v136, v208
    v_mul_f32 v73, v73, v212
    v_fmac_f32 v73, v137, v208
    v_mul_f32 v74, v74, v212
    v_fmac_f32 v74, v138, v208
    v_mul_f32 v75, v75, v212
    v_fmac_f32 v75, v139, v208
    v_mul_f32 v76, v76, v212
    v_fmac_f32 v76, v140, v208
    v_mul_f32 v77, v77, v212
    v_fmac_f32 v77, v141, v208
    v_mul_f32 v78, v78, v212
    v_fmac_f32 v78, v142, v208
    v_mul_f32 v79, v79, v212
    v_fmac_f32 v79, v143, v208
    s_lshl_b32 s48, s42, 2
    s_add_u32 s48, s48, s39
    s_lshl_b32 s48, s48, 18
    s_lshl_b32 s53, s36, 13
    s_add_u32 s48, s48, s53
    v_cvt_pk_bf16_f32 v160, v48, v49
    v_cvt_pk_bf16_f32 v161, v50, v51
    v_cvt_pk_bf16_f32 v162, v52, v53
    v_cvt_pk_bf16_f32 v163, v54, v55
    s_add_u32 s53, s48, 0
    buffer_store_dwordx4 v[160:163], v5, s[20:23], s53 offen
    v_cvt_pk_bf16_f32 v164, v56, v57
    v_cvt_pk_bf16_f32 v165, v58, v59
    v_cvt_pk_bf16_f32 v166, v60, v61
    v_cvt_pk_bf16_f32 v167, v62, v63
    s_add_u32 s53, s48, 1024
    buffer_store_dwordx4 v[164:167], v5, s[20:23], s53 offen
    v_cvt_pk_bf16_f32 v168, v64, v65
    v_cvt_pk_bf16_f32 v169, v66, v67
    v_cvt_pk_bf16_f32 v170, v68, v69
    v_cvt_pk_bf16_f32 v171, v70, v71
    s_add_u32 s53, s48, 2048
    buffer_store_dwordx4 v[168:171], v5, s[20:23], s53 offen
    v_cvt_pk_bf16_f32 v172, v72, v73
    v_cvt_pk_bf16_f32 v173, v74, v75
    v_cvt_pk_bf16_f32 v174, v76, v77
    v_cvt_pk_bf16_f32 v175, v78, v79
    s_add_u32 s53, s48, 3072
    buffer_store_dwordx4 v[172:175], v5, s[20:23], s53 offen
    s_branch .Lattn_k_mgd_20
.Lattn_k_mg1_19:
    ds_write_b128 v11, v[48:51] offset:0
    ds_write_b128 v11, v[52:55] offset:1024
    ds_write_b128 v11, v[56:59] offset:2048
    ds_write_b128 v11, v[60:63] offset:3072
    ds_write_b128 v11, v[64:67] offset:4096
    ds_write_b128 v11, v[68:71] offset:5120
    ds_write_b128 v11, v[72:75] offset:6144
    ds_write_b128 v11, v[76:79] offset:7168
    s_waitcnt lgkmcnt(0)
    s_barrier
    ds_read_b64 v[208:209], v13
    ds_read_b128 v[112:115], v12 offset:0
    ds_read_b128 v[116:119], v12 offset:1024
    ds_read_b128 v[120:123], v12 offset:2048
    ds_read_b128 v[124:127], v12 offset:3072
    ds_read_b128 v[128:131], v12 offset:4096
    ds_read_b128 v[132:135], v12 offset:5120
    ds_read_b128 v[136:139], v12 offset:6144
    ds_read_b128 v[140:143], v12 offset:7168
    s_waitcnt lgkmcnt(8)
    v_max_f32 v10, v212, v208
    v_sub_f32 v212, v212, v10
    v_sub_f32 v208, v208, v10
    v_exp_f32 v212, v212
    v_exp_f32 v208, v208
    s_nop 0
    v_mul_f32 v10, v212, v213
    v_fmac_f32 v10, v208, v209
    v_rcp_f32 v10, v10
    s_nop 0
    v_mul_f32 v212, v212, v10
    v_mul_f32 v208, v208, v10
    s_waitcnt lgkmcnt(0)
    v_mul_f32 v80, v80, v212
    v_fmac_f32 v80, v112, v208
    v_mul_f32 v81, v81, v212
    v_fmac_f32 v81, v113, v208
    v_mul_f32 v82, v82, v212
    v_fmac_f32 v82, v114, v208
    v_mul_f32 v83, v83, v212
    v_fmac_f32 v83, v115, v208
    v_mul_f32 v84, v84, v212
    v_fmac_f32 v84, v116, v208
    v_mul_f32 v85, v85, v212
    v_fmac_f32 v85, v117, v208
    v_mul_f32 v86, v86, v212
    v_fmac_f32 v86, v118, v208
    v_mul_f32 v87, v87, v212
    v_fmac_f32 v87, v119, v208
    v_mul_f32 v88, v88, v212
    v_fmac_f32 v88, v120, v208
    v_mul_f32 v89, v89, v212
    v_fmac_f32 v89, v121, v208
    v_mul_f32 v90, v90, v212
    v_fmac_f32 v90, v122, v208
    v_mul_f32 v91, v91, v212
    v_fmac_f32 v91, v123, v208
    v_mul_f32 v92, v92, v212
    v_fmac_f32 v92, v124, v208
    v_mul_f32 v93, v93, v212
    v_fmac_f32 v93, v125, v208
    v_mul_f32 v94, v94, v212
    v_fmac_f32 v94, v126, v208
    v_mul_f32 v95, v95, v212
    v_fmac_f32 v95, v127, v208
    v_mul_f32 v96, v96, v212
    v_fmac_f32 v96, v128, v208
    v_mul_f32 v97, v97, v212
    v_fmac_f32 v97, v129, v208
    v_mul_f32 v98, v98, v212
    v_fmac_f32 v98, v130, v208
    v_mul_f32 v99, v99, v212
    v_fmac_f32 v99, v131, v208
    v_mul_f32 v100, v100, v212
    v_fmac_f32 v100, v132, v208
    v_mul_f32 v101, v101, v212
    v_fmac_f32 v101, v133, v208
    v_mul_f32 v102, v102, v212
    v_fmac_f32 v102, v134, v208
    v_mul_f32 v103, v103, v212
    v_fmac_f32 v103, v135, v208
    v_mul_f32 v104, v104, v212
    v_fmac_f32 v104, v136, v208
    v_mul_f32 v105, v105, v212
    v_fmac_f32 v105, v137, v208
    v_mul_f32 v106, v106, v212
    v_fmac_f32 v106, v138, v208
    v_mul_f32 v107, v107, v212
    v_fmac_f32 v107, v139, v208
    v_mul_f32 v108, v108, v212
    v_fmac_f32 v108, v140, v208
    v_mul_f32 v109, v109, v212
    v_fmac_f32 v109, v141, v208
    v_mul_f32 v110, v110, v212
    v_fmac_f32 v110, v142, v208
    v_mul_f32 v111, v111, v212
    v_fmac_f32 v111, v143, v208
    s_lshl_b32 s48, s42, 2
    s_add_u32 s48, s48, s39
    s_lshl_b32 s48, s48, 18
    s_lshl_b32 s53, s36, 13
    s_add_u32 s48, s48, s53
    v_cvt_pk_bf16_f32 v160, v80, v81
    v_cvt_pk_bf16_f32 v161, v82, v83
    v_cvt_pk_bf16_f32 v162, v84, v85
    v_cvt_pk_bf16_f32 v163, v86, v87
    s_add_u32 s53, s48, 4096
    buffer_store_dwordx4 v[160:163], v5, s[20:23], s53 offen
    v_cvt_pk_bf16_f32 v164, v88, v89
    v_cvt_pk_bf16_f32 v165, v90, v91
    v_cvt_pk_bf16_f32 v166, v92, v93
    v_cvt_pk_bf16_f32 v167, v94, v95
    s_add_u32 s53, s48, 5120
    buffer_store_dwordx4 v[164:167], v5, s[20:23], s53 offen
    v_cvt_pk_bf16_f32 v168, v96, v97
    v_cvt_pk_bf16_f32 v169, v98, v99
    v_cvt_pk_bf16_f32 v170, v100, v101
    v_cvt_pk_bf16_f32 v171, v102, v103
    s_add_u32 s53, s48, 6144
    buffer_store_dwordx4 v[168:171], v5, s[20:23], s53 offen
    v_cvt_pk_bf16_f32 v172, v104, v105
    v_cvt_pk_bf16_f32 v173, v106, v107
    v_cvt_pk_bf16_f32 v174, v108, v109
    v_cvt_pk_bf16_f32 v175, v110, v111
    s_add_u32 s53, s48, 7168
    buffer_store_dwordx4 v[172:175], v5, s[20:23], s53 offen
.Lattn_k_mgd_20:
    s_barrier
    s_add_u32 s52, s52, 1
    s_mov_b32 s42, s37
    s_cmp_lt_u32 s52, 2
    s_cbranch_scc1 .Lattn_k_blk_6
    s_branch .Lattn_k_end_1
.Lattn_k_slow_2:
    v_mov_b32 v10, v212
    s_nop 1
    v_permlane32_swap_b32 v212, v10
    s_nop 1
    v_max_f32 v212, v212, v10
    s_cmp_lg_u32 s47, 0
    s_cbranch_scc1 .Lattn_k_dn_22
    v_max_f32 v212, 0, v212
    v_sub_f32 v10, 0, v212
    v_exp_f32 v10, v10
    s_nop 0
    v_mul_f32 v48, v48, v10
    v_mul_f32 v49, v49, v10
    v_mul_f32 v50, v50, v10
    v_mul_f32 v51, v51, v10
    v_mul_f32 v52, v52, v10
    v_mul_f32 v53, v53, v10
    v_mul_f32 v54, v54, v10
    v_mul_f32 v55, v55, v10
    v_mul_f32 v56, v56, v10
    v_mul_f32 v57, v57, v10
    v_mul_f32 v58, v58, v10
    v_mul_f32 v59, v59, v10
    v_mul_f32 v60, v60, v10
    v_mul_f32 v61, v61, v10
    v_mul_f32 v62, v62, v10
    v_mul_f32 v63, v63, v10
    v_mul_f32 v64, v64, v10
    v_mul_f32 v65, v65, v10
    v_mul_f32 v66, v66, v10
    v_mul_f32 v67, v67, v10
    v_mul_f32 v68, v68, v10
    v_mul_f32 v69, v69, v10
    v_mul_f32 v70, v70, v10
    v_mul_f32 v71, v71, v10
    v_mul_f32 v72, v72, v10
    v_mul_f32 v73, v73, v10
    v_mul_f32 v74, v74, v10
    v_mul_f32 v75, v75, v10
    v_mul_f32 v76, v76, v10
    v_mul_f32 v77, v77, v10
    v_mul_f32 v78, v78, v10
    v_mul_f32 v79, v79, v10
    v_mul_f32 v80, v80, v10
    v_mul_f32 v81, v81, v10
    v_mul_f32 v82, v82, v10
    v_mul_f32 v83, v83, v10
    v_mul_f32 v84, v84, v10
    v_mul_f32 v85, v85, v10
    v_mul_f32 v86, v86, v10
    v_mul_f32 v87, v87, v10
    v_mul_f32 v88, v88, v10
    v_mul_f32 v89, v89, v10
    v_mul_f32 v90, v90, v10
    v_mul_f32 v91, v91, v10
    v_mul_f32 v92, v92, v10
    v_mul_f32 v93, v93, v10
    v_mul_f32 v94, v94, v10
    v_mul_f32 v95, v95, v10
    v_mul_f32 v96, v96, v10
    v_mul_f32 v97, v97, v10
    v_mul_f32 v98, v98, v10
    v_mul_f32 v99, v99, v10
    v_mul_f32 v100, v100, v10
    v_mul_f32 v101, v101, v10
    v_mul_f32 v102, v102, v10
    v_mul_f32 v103, v103, v10
    v_mul_f32 v104, v104, v10
    v_mul_f32 v105, v105, v10
    v_mul_f32 v106, v106, v10
    v_mul_f32 v107, v107, v10
    v_mul_f32 v108, v108, v10
    v_mul_f32 v109, v109, v10
    v_mul_f32 v110, v110, v10
    v_mul_f32 v111, v111, v10
    v_mul_f32 v208, v208, v10
    v_mul_f32 v209, v209, v10
    v_mul_f32 v210, v210, v10
    v_mul_f32 v211, v211, v10
.Lattn_k_dn_22:
    s_mov_b32 s47, 0
    v_sub_f32 v112, v112, v212
    v_sub_f32 v113, v113, v212
    v_sub_f32 v114, v114, v212
    v_sub_f32 v115, v115, v212
    v_sub_f32 v116, v116, v212
    v_sub_f32 v117, v117, v212
    v_sub_f32 v118, v118, v212
    v_sub_f32 v119, v119, v212
    v_sub_f32 v120, v120, v212
    v_sub_f32 v121, v121, v212
    v_sub_f32 v122, v122, v212
    v_sub_f32 v123, v123, v212
    v_sub_f32 v124, v124, v212
    v_sub_f32 v125, v125, v212
    v_sub_f32 v126, v126, v212
    v_sub_f32 v127, v127, v212
    v_sub_f32 v128, v128, v212
    v_sub_f32 v129, v129, v212
    v_sub_f32 v130, v130, v212
    v_sub_f32 v131, v131, v212
    v_sub_f32 v132, v132, v212
    v_sub_f32 v133, v133, v212
    v_sub_f32 v134, v134, v212
    v_sub_f32 v135, v135, v212
    v_sub_f32 v136, v136, v212
    v_sub_f32 v137, v137, v212
    v_sub_f32 v138, v138, v212
    v_sub_f32 v139, v139, v212
    v_sub_f32 v140, v140, v212
    v_sub_f32 v141, v141, v212
    v_sub_f32 v142, v142, v212
    v_sub_f32 v143, v143, v212
    v_sub_f32 v144, v144, v212
    v_sub_f32 v145, v145, v212
    v_sub_f32 v146, v146, v212
    v_sub_f32 v147, v147, v212
    v_sub_f32 v148, v148, v212
    v_sub_f32 v149, v149, v212
    v_sub_f32 v150, v150, v212
    v_sub_f32 v151, v151, v212
    v_sub_f32 v152, v152, v212
    v_sub_f32 v153, v153, v212
    v_sub_f32 v154, v154, v212
    v_sub_f32 v155, v155, v212
    v_sub_f32 v156, v156, v212
    v_sub_f32 v157, v157, v212
    v_sub_f32 v158, v158, v212
    v_sub_f32 v159, v159, v212
    s_branch .Lattn_k_back_3
.Lattn_k_slow_4:
    v_mov_b32 v10, v212
    s_nop 1
    v_permlane32_swap_b32 v212, v10
    s_nop 1
    v_max_f32 v212, v212, v10
    s_cmp_lg_u32 s47, 0
    s_cbranch_scc1 .Lattn_k_dn_24
    v_max_f32 v212, 0, v212
    v_sub_f32 v10, 0, v212
    v_exp_f32 v10, v10
    s_nop 0
    v_mul_f32 v48, v48, v10
    v_mul_f32 v49, v49, v10
    v_mul_f32 v50, v50, v10
    v_mul_f32 v51, v51, v10
    v_mul_f32 v52, v52, v10
    v_mul_f32 v53, v53, v10
    v_mul_f32 v54, v54, v10
    v_mul_f32 v55, v55, v10
    v_mul_f32 v56, v56, v10
    v_mul_f32 v57, v57, v10
    v_mul_f32 v58, v58, v10
    v_mul_f32 v59, v59, v10
    v_mul_f32 v60, v60, v10
    v_mul_f32 v61, v61, v10
    v_mul_f32 v62, v62, v10
    v_mul_f32 v63, v63, v10
    v_mul_f32 v64, v64, v10
    v_mul_f32 v65, v65, v10
    v_mul_f32 v66, v66, v10
    v_mul_f32 v67, v67, v10
    v_mul_f32 v68, v68, v10
    v_mul_f32 v69, v69, v10
    v_mul_f32 v70, v70, v10
    v_mul_f32 v71, v71, v10
    v_mul_f32 v72, v72, v10
    v_mul_f32 v73, v73, v10
    v_mul_f32 v74, v74, v10
    v_mul_f32 v75, v75, v10
    v_mul_f32 v76, v76, v10
    v_mul_f32 v77, v77, v10
    v_mul_f32 v78, v78, v10
    v_mul_f32 v79, v79, v10
    v_mul_f32 v80, v80, v10
    v_mul_f32 v81, v81, v10
    v_mul_f32 v82, v82, v10
    v_mul_f32 v83, v83, v10
    v_mul_f32 v84, v84, v10
    v_mul_f32 v85, v85, v10
    v_mul_f32 v86, v86, v10
    v_mul_f32 v87, v87, v10
    v_mul_f32 v88, v88, v10
    v_mul_f32 v89, v89, v10
    v_mul_f32 v90, v90, v10
    v_mul_f32 v91, v91, v10
    v_mul_f32 v92, v92, v10
    v_mul_f32 v93, v93, v10
    v_mul_f32 v94, v94, v10
    v_mul_f32 v95, v95, v10
    v_mul_f32 v96, v96, v10
    v_mul_f32 v97, v97, v10
    v_mul_f32 v98, v98, v10
    v_mul_f32 v99, v99, v10
    v_mul_f32 v100, v100, v10
    v_mul_f32 v101, v101, v10
    v_mul_f32 v102, v102, v10
    v_mul_f32 v103, v103, v10
    v_mul_f32 v104, v104, v10
    v_mul_f32 v105, v105, v10
    v_mul_f32 v106, v106, v10
    v_mul_f32 v107, v107, v10
    v_mul_f32 v108, v108, v10
    v_mul_f32 v109, v109, v10
    v_mul_f32 v110, v110, v10
    v_mul_f32 v111, v111, v10
    v_mul_f32 v208, v208, v10
    v_mul_f32 v209, v209, v10
    v_mul_f32 v210, v210, v10
    v_mul_f32 v211, v211, v10
.Lattn_k_dn_24:
    s_mov_b32 s47, 0
    v_sub_f32 v112, v112, v212
    v_sub_f32 v113, v113, v212
    v_sub_f32 v114, v114, v212
    v_sub_f32 v115, v115, v212
    v_sub_f32 v116, v116, v212
    v_sub_f32 v117, v117, v212
    v_sub_f32 v118, v118, v212
    v_sub_f32 v119, v119, v212
    v_sub_f32 v120, v120, v212
    v_sub_f32 v121, v121, v212
    v_sub_f32 v122, v122, v212
    v_sub_f32 v123, v123, v212
    v_sub_f32 v124, v124, v212
    v_sub_f32 v125, v125, v212
    v_sub_f32 v126, v126, v212
    v_sub_f32 v127, v127, v212
    v_sub_f32 v128, v128, v212
    v_sub_f32 v129, v129, v212
    v_sub_f32 v130, v130, v212
    v_sub_f32 v131, v131, v212
    v_sub_f32 v132, v132, v212
    v_sub_f32 v133, v133, v212
    v_sub_f32 v134, v134, v212
    v_sub_f32 v135, v135, v212
    v_sub_f32 v136, v136, v212
    v_sub_f32 v137, v137, v212
    v_sub_f32 v138, v138, v212
    v_sub_f32 v139, v139, v212
    v_sub_f32 v140, v140, v212
    v_sub_f32 v141, v141, v212
    v_sub_f32 v142, v142, v212
    v_sub_f32 v143, v143, v212
    v_sub_f32 v144, v144, v212
    v_sub_f32 v145, v145, v212
    v_sub_f32 v146, v146, v212
    v_sub_f32 v147, v147, v212
    v_sub_f32 v148, v148, v212
    v_sub_f32 v149, v149, v212
    v_sub_f32 v150, v150, v212
    v_sub_f32 v151, v151, v212
    v_sub_f32 v152, v152, v212
    v_sub_f32 v153, v153, v212
    v_sub_f32 v154, v154, v212
    v_sub_f32 v155, v155, v212
    v_sub_f32 v156, v156, v212
    v_sub_f32 v157, v157, v212
    v_sub_f32 v158, v158, v212
    v_sub_f32 v159, v159, v212
    s_branch .Lattn_k_back_5
.Lattn_k_end_1:
    s_endpgm
.globl oproj_kernel
.p2align 8
.type oproj_kernel,@function
oproj_kernel:
    s_cmp_ge_u32 s2, 256
    s_cbranch_scc1 .Loproj__end_1
    v_and_b32 v1, 63, v0
    v_lshrrev_b32 v2, 6, v0
    s_nop 0
    v_readfirstlane_b32 s3, v2
    s_load_dwordx2 s[8:9], s[0:1], 104
    s_load_dwordx2 s[12:13], s[0:1], 40
    s_load_dwordx2 s[20:21], s[0:1], 104
    s_waitcnt lgkmcnt(0)
    s_add_u32 s8, s8, 0x3200000
    s_addc_u32 s9, s9, 0
    s_and_b32 s9, s9, 0xffff
    s_mov_b32 s10, 0x1000000
    s_mov_b32 s11, 0x20000
    s_and_b32 s13, s13, 0xffff
    s_mov_b32 s14, 0x400000
    s_mov_b32 s15, 0x20000
    s_add_u32 s20, s20, 0x4200000
    s_addc_u32 s21, s21, 0
    s_and_b32 s21, s21, 0xffff
    s_mov_b32 s22, 0x1000000
    s_mov_b32 s23, 0x20000
    s_and_b32 s36, s2, 1
    s_lshl_b32 s36, s36, 3
    s_bfe_u32 s37, s2, 0x30003
    s_add_u32 s36, s36, s37
    s_lshr_b32 s37, s2, 6
    s_bfe_u32 s40, s2, 0x20001
    s_lshr_b32 s38, s3, 2
    s_and_b32 s39, s3, 3
    v_lshlrev_b32 v3, 4, v1
    s_lshr_b32 s45, s3, 1
    s_lshl_b32 s45, s45, 18
    s_and_b32 s46, s3, 1
    s_lshl_b32 s46, s46, 11
    s_add_u32 s45, s45, s46
    v_add_u32 v4, s45, v3
    s_lshl_b32 s41, s36, 20
    s_lshl_b32 s45, s40, 16
    s_add_u32 s41, s41, s45
    v_lshl_add_u32 v5, v2, 1, 0
    v_lshrrev_b32 v8, 4, v1
    v_and_b32 v9, 15, v1
    v_mul_u32_u24 v10, 4, v5
    v_add_u32 v8, v8, v10
    v_and_b32 v10, 3, v8
    v_lshlrev_b32 v10, 2, v10
    v_xor_b32 v9, v9, v10
    v_lshlrev_b32 v9, 4, v9
    s_mov_b32 s60, 1024
    v_mul_lo_u32 v6, s60, v8
    v_add_u32 v6, v6, v9
    v_lshl_add_u32 v5, v2, 1, 1
    v_lshrrev_b32 v8, 4, v1
    v_and_b32 v9, 15, v1
    v_mul_u32_u24 v10, 4, v5
    v_add_u32 v8, v8, v10
    v_and_b32 v10, 3, v8
    v_lshlrev_b32 v10, 2, v10
    v_xor_b32 v9, v9, v10
    v_lshlrev_b32 v9, 4, v9
    s_mov_b32 s60, 1024
    v_mul_lo_u32 v7, s60, v8
    v_add_u32 v7, v7, v9
    s_lshl_b32 s42, s40, 20
    s_lshl_b32 s45, s37, 8
    s_add_u32 s42, s42, s45
    s_lshl_b32 s43, s3, 11
    s_add_u32 s44, s43, 16384
    s_lshl_b32 s45, s39, 12
    v_add_u32 v8, s45, v3
    v_add_u32 v9, 0x10000, v8
    v_bfe_u32 v14, v1, 2, 2
    v_lshrrev_b32 v15, 5, v1
    v_lshlrev_b32 v15, 2, v15
    v_add_u32 v15, v15, v14
    v_mul_u32_u24 v10, 256, v15
    v_xor_b32 v14, 0, v14
    v_lshlrev_b32 v14, 6, v14
    v_add_u32 v10, v10, v14
    v_bfe_u32 v14, v1, 4, 1
    v_lshlrev_b32 v14, 5, v14
    v_add_u32 v10, v10, v14
    v_and_b32 v14, 3, v1
    v_lshlrev_b32 v14, 3, v14
    v_add_u32 v10, v10, v14
    s_lshl_b32 s45, s38, 7
    v_xor_b32 v10, s45, v10
    v_add_u32 v10, 16384, v10
    v_add_u32 v11, 0x10000, v10
    v_bfe_u32 v14, v1, 2, 2
    v_lshrrev_b32 v15, 5, v1
    v_lshlrev_b32 v15, 2, v15
    v_add_u32 v15, v15, v14
    v_mul_u32_u24 v12, 256, v15
    v_xor_b32 v14, 1, v14
    v_lshlrev_b32 v14, 6, v14
    v_add_u32 v12, v12, v14
    v_bfe_u32 v14, v1, 4, 1
    v_lshlrev_b32 v14, 5, v14
    v_add_u32 v12, v12, v14
    v_and_b32 v14, 3, v1
    v_lshlrev_b32 v14, 3, v14
    v_add_u32 v12, v12, v14
    s_lshl_b32 s45, s38, 7
    v_xor_b32 v12, s45, v12
    v_add_u32 v12, 16384, v12
    v_add_u32 v13, 0x10000, v12
    v_mov_b32 v16, 0
    v_mov_b32 v17, 0
    v_mov_b32 v18, 0
    v_mov_b32 v19, 0
    v_mov_b32 v20, 0
    v_mov_b32 v21, 0
    v_mov_b32 v22, 0
    v_mov_b32 v23, 0
    v_mov_b32 v24, 0
    v_mov_b32 v25, 0
    v_mov_b32 v26, 0
    v_mov_b32 v27, 0
    v_mov_b32 v28, 0
    v_mov_b32 v29, 0
    v_mov_b32 v30, 0
    v_mov_b32 v31, 0
    v_mov_b32 v32, 0
    v_mov_b32 v33, 0
    v_mov_b32 v34, 0
    v_mov_b32 v35, 0
    v_mov_b32 v36, 0
    v_mov_b32 v37, 0
    v_mov_b32 v38, 0
    v_mov_b32 v39, 0
    v_mov_b32 v40, 0
    v_mov_b32 v41, 0
    v_mov_b32 v42, 0
    v_mov_b32 v43, 0
    v_mov_b32 v44, 0
    v_mov_b32 v45, 0
    v_mov_b32 v46, 0
    v_mov_b32 v47, 0
    s_add_u32 m0, s43, 0x0
    s_nop 0
    buffer_load_dwordx4 v4, s[8:11], s41 offen offset:0 lds
    buffer_load_dwordx4 v4, s[8:11], s41 offen offset:1024 lds
    s_add_u32 m0, s44, 0x0
    s_nop 0
    buffer_load_dwordx4 v6, s[12:15], s42 offen lds
    s_add_u32 m0, s44, 0x400
    s_nop 0
    buffer_load_dwordx4 v7, s[12:15], s42 offen lds
    s_add_u32 s41, s41, 4096
    s_add_u32 s42, s42, 0x10000
    s_add_u32 m0, s43, 0x8000
    s_nop 0
    buffer_load_dwordx4 v4, s[8:11], s41 offen offset:0 lds
    buffer_load_dwordx4 v4, s[8:11], s41 offen offset:1024 lds
    s_add_u32 m0, s44, 0x8000
    s_nop 0
    buffer_load_dwordx4 v6, s[12:15], s42 offen lds
    s_add_u32 m0, s44, 0x8400
    s_nop 0
    buffer_load_dwordx4 v7, s[12:15], s42 offen lds
    s_add_u32 s41, s41, 4096
    s_add_u32 s42, s42, 0x10000
    s_add_u32 m0, s43, 0x10000
    s_nop 0
    buffer_load_dwordx4 v4, s[8:11], s41 offen offset:0 lds
    buffer_load_dwordx4 v4, s[8:11], s41 offen offset:1024 lds
    s_add_u32 m0, s44, 0x10000
    s_nop 0
    buffer_load_dwordx4 v6, s[12:15], s42 offen lds
    s_add_u32 m0, s44, 0x10400
    s_nop 0
    buffer_load_dwordx4 v7, s[12:15], s42 offen lds
    s_add_u32 s41, s41, 4096
    s_add_u32 s42, s42, 0x10000
    s_waitcnt vmcnt(8) lgkmcnt(0)
    s_barrier
    ds_read_b64_tr_b16 v[48:49], v10 offset:0
    ds_read_b64_tr_b16 v[50:51], v10 offset:2048
    ds_read_b64_tr_b16 v[52:53], v12 offset:0
    ds_read_b64_tr_b16 v[54:55], v12 offset:2048
    ds_read_b128 v[56:59], v8 offset:0
    ds_read_b64_tr_b16 v[60:61], v10 offset:4096
    ds_read_b64_tr_b16 v[62:63], v10 offset:6144
    ds_read_b64_tr_b16 v[64:65], v12 offset:4096
    ds_read_b64_tr_b16 v[66:67], v12 offset:6144
    ds_read_b128 v[68:71], v8 offset:1024
    s_waitcnt lgkmcnt(5)
    v_mfma_f32_32x32x16_bf16 v[16:31], v[48:51], v[56:59], v[16:31]
    ds_read_b64_tr_b16 v[72:73], v10 offset:8192
    ds_read_b64_tr_b16 v[74:75], v10 offset:10240
    ds_read_b64_tr_b16 v[76:77], v12 offset:8192
    ds_read_b64_tr_b16 v[78:79], v12 offset:10240
    ds_read_b128 v[80:83], v8 offset:2048
    s_add_u32 m0, s43, 0x18000
    s_nop 0
    buffer_load_dwordx4 v4, s[8:11], s41 offen offset:0 lds
    v_mfma_f32_32x32x16_bf16 v[32:47], v[52:55], v[56:59], v[32:47]
    buffer_load_dwordx4 v4, s[8:11], s41 offen offset:1024 lds
    s_add_u32 m0, s44, 0x18000
    s_nop 0
    s_waitcnt lgkmcnt(5)
    v_mfma_f32_32x32x16_bf16 v[16:31], v[60:63], v[68:71], v[16:31]
    ds_read_b64_tr_b16 v[48:49], v10 offset:12288
    ds_read_b64_tr_b16 v[50:51], v10 offset:14336
    ds_read_b64_tr_b16 v[52:53], v12 offset:12288
    ds_read_b64_tr_b16 v[54:55], v12 offset:14336
    ds_read_b128 v[56:59], v8 offset:3072
    buffer_load_dwordx4 v6, s[12:15], s42 offen lds
    s_add_u32 m0, s44, 0x18400
    s_nop 0
    v_mfma_f32_32x32x16_bf16 v[32:47], v[64:67], v[68:71], v[32:47]
    buffer_load_dwordx4 v7, s[12:15], s42 offen lds
    s_add_u32 s41, s41, 4096
    s_add_u32 s42, s42, 0x10000
    s_waitcnt vmcnt(8) lgkmcnt(0)
    s_barrier
    v_mfma_f32_32x32x16_bf16 v[16:31], v[72:75], v[80:83], v[16:31]
    ds_read_b64_tr_b16 v[60:61], v10 offset:32768
    ds_read_b64_tr_b16 v[62:63], v10 offset:34816
    ds_read_b64_tr_b16 v[64:65], v12 offset:32768
    ds_read_b64_tr_b16 v[66:67], v12 offset:34816
    ds_read_b128 v[68:71], v8 offset:32768
    s_add_u32 m0, s43, 0x0
    s_nop 0
    buffer_load_dwordx4 v4, s[8:11], s41 offen offset:0 lds
    v_mfma_f32_32x32x16_bf16 v[32:47], v[76:79], v[80:83], v[32:47]
    buffer_load_dwordx4 v4, s[8:11], s41 offen offset:1024 lds
    s_add_u32 m0, s44, 0x0
    s_nop 0
    s_waitcnt lgkmcnt(5)
    v_mfma_f32_32x32x16_bf16 v[16:31], v[48:51], v[56:59], v[16:31]
    ds_read_b64_tr_b16 v[72:73], v10 offset:36864
    ds_read_b64_tr_b16 v[74:75], v10 offset:38912
    ds_read_b64_tr_b16 v[76:77], v12 offset:36864
    ds_read_b64_tr_b16 v[78:79], v12 offset:38912
    ds_read_b128 v[80:83], v8 offset:33792
    buffer_load_dwordx4 v6, s[12:15], s42 offen lds
    s_add_u32 m0, s44, 0x400
    s_nop 0
    v_mfma_f32_32x32x16_bf16 v[32:47], v[52:55], v[56:59], v[32:47]
    buffer_load_dwordx4 v7, s[12:15], s42 offen lds
    s_add_u32 s41, s41, 4096
    s_waitcnt lgkmcnt(5)
    v_mfma_f32_32x32x16_bf16 v[16:31], v[60:63], v[68:71], v[16:31]
    ds_read_b64_tr_b16 v[48:49], v10 offset:40960
    ds_read_b64_tr_b16 v[50:51], v10 offset:43008
    ds_read_b64_tr_b16 v[52:53], v12 offset:40960
    ds_read_b64_tr_b16 v[54:55], v12 offset:43008
    ds_read_b128 v[56:59], v8 offset:34816
    s_add_u32 s42, s42, 0x10000
    v_mfma_f32_32x32x16_bf16 v[32:47], v[64:67], v[68:71], v[32:47]
    s_waitcnt lgkmcnt(5)
    v_mfma_f32_32x32x16_bf16 v[16:31], v[72:75], v[80:83], v[16:31]
    ds_read_b64_tr_b16 v[60:61], v10 offset:45056
    ds_read_b64_tr_b16 v[62:63], v10 offset:47104
    ds_read_b64_tr_b16 v[64:65], v12 offset:45056
    ds_read_b64_tr_b16 v[66:67], v12 offset:47104
    ds_read_b128 v[68:71], v8 offset:35840
    v_mfma_f32_32x32x16_bf16 v[32:47], v[76:79], v[80:83], v[32:47]
    s_waitcnt vmcnt(8) lgkmcnt(0)
    s_barrier
    v_mfma_f32_32x32x16_bf16 v[16:31], v[48:51], v[56:59], v[16:31]
    ds_read_b64_tr_b16 v[72:73], v11 offset:0
    ds_read_b64_tr_b16 v[74:75], v11 offset:2048
    ds_read_b64_tr_b16 v[76:77], v13 offset:0
    ds_read_b64_tr_b16 v[78:79], v13 offset:2048
    ds_read_b128 v[80:83], v9 offset:0
    s_add_u32 m0, s43, 0x8000
    s_nop 0
    buffer_load_dwordx4 v4, s[8:11], s41 offen offset:0 lds
    v_mfma_f32_32x32x16_bf16 v[32:47], v[52:55], v[56:59], v[32:47]
    buffer_load_dwordx4 v4, s[8:11], s41 offen offset:1024 lds
    s_add_u32 m0, s44, 0x8000
    s_nop 0
    s_waitcnt lgkmcnt(5)
    v_mfma_f32_32x32x16_bf16 v[16:31], v[60:63], v[68:71], v[16:31]
    ds_read_b64_tr_b16 v[48:49], v11 offset:4096
    ds_read_b64_tr_b16 v[50:51], v11 offset:6144
    ds_read_b64_tr_b16 v[52:53], v13 offset:4096
    ds_read_b64_tr_b16 v[54:55], v13 offset:6144
    ds_read_b128 v[56:59], v9 offset:1024
    buffer_load_dwordx4 v6, s[12:15], s42 offen lds
    s_add_u32 m0, s44, 0x8400
    s_nop 0
    v_mfma_f32_32x32x16_bf16 v[32:47], v[64:67], v[68:71], v[32:47]
    buffer_load_dwordx4 v7, s[12:15], s42 offen lds
    s_add_u32 s41, s41, 4096
    s_waitcnt lgkmcnt(5)
    v_mfma_f32_32x32x16_bf16 v[16:31], v[72:75], v[80:83], v[16:31]
    ds_read_b64_tr_b16 v[60:61], v11 offset:8192
    ds_read_b64_tr_b16 v[62:63], v11 offset:10240
    ds_read_b64_tr_b16 v[64:65], v13 offset:8192
    ds_read_b64_tr_b16 v[66:67], v13 offset:10240
    ds_read_b128 v[68:71], v9 offset:2048
    s_add_u32 s42, s42, 0x10000
    v_mfma_f32_32x32x16_bf16 v[32:47], v[76:79], v[80:83], v[32:47]
    s_waitcnt lgkmcnt(5)
    v_mfma_f32_32x32x16_bf16 v[16:31], v[48:51], v[56:59], v[16:31]
    ds_read_b64_tr_b16 v[72:73], v11 offset:12288
    ds_read_b64_tr_b16 v[74:75], v11 offset:14336
    ds_read_b64_tr_b16 v[76:77], v13 offset:12288
    ds_read_b64_tr_b16 v[78:79], v13 offset:14336
    ds_read_b128 v[80:83], v9 offset:3072
    v_mfma_f32_32x32x16_bf16 v[32:47], v[52:55], v[56:59], v[32:47]
    s_waitcnt vmcnt(8) lgkmcnt(0)
    s_barrier
    v_mfma_f32_32x32x16_bf16 v[16:31], v[60:63], v[68:71], v[16:31]
    ds_read_b64_tr_b16 v[48:49], v11 offset:32768
    ds_read_b64_tr_b16 v[50:51], v11 offset:34816
    ds_read_b64_tr_b16 v[52:53], v13 offset:32768
    ds_read_b64_tr_b16 v[54:55], v13 offset:34816
    ds_read_b128 v[56:59], v9 offset:32768
    s_add_u32 m0, s43, 0x10000
    s_nop 0
    buffer_load_dwordx4 v4, s[8:11], s41 offen offset:0 lds
    v_mfma_f32_32x32x16_bf16 v[32:47], v[64:67], v[68:71], v[32:47]
    buffer_load_dwordx4 v4, s[8:11], s41 offen offset:1024 lds
    s_add_u32 m0, s44, 0x10000
    s_nop 0
    s_waitcnt lgkmcnt(5)
    v_mfma_f32_32x32x16_bf16 v[16:31], v[72:75], v[80:83], v[16:31]
    ds_read_b64_tr_b16 v[60:61], v11 offset:36864
    ds_read_b64_tr_b16 v[62:63], v11 offset:38912
    ds_read_b64_tr_b16 v[64:65], v13 offset:36864
    ds_read_b64_tr_b16 v[66:67], v13 offset:38912
    ds_read_b128 v[68:71], v9 offset:33792
    buffer_load_dwordx4 v6, s[12:15], s42 offen lds
    s_add_u32 m0, s44, 0x10400
    s_nop 0
    v_mfma_f32_32x32x16_bf16 v[32:47], v[76:79], v[80:83], v[32:47]
    buffer_load_dwordx4 v7, s[12:15], s42 offen lds
    s_add_u32 s41, s41, 4096
    s_waitcnt lgkmcnt(5)
    v_mfma_f32_32x32x16_bf16 v[16:31], v[48:51], v[56:59], v[16:31]
    ds_read_b64_tr_b16 v[72:73], v11 offset:40960
    ds_read_b64_tr_b16 v[74:75], v11 offset:43008
    ds_read_b64_tr_b16 v[76:77], v13 offset:40960
    ds_read_b64_tr_b16 v[78:79], v13 offset:43008
    ds_read_b128 v[80:83], v9 offset:34816
    s_add_u32 s42, s42, 0x10000
    v_mfma_f32_32x32x16_bf16 v[32:47], v[52:55], v[56:59], v[32:47]
    s_waitcnt lgkmcnt(5)
    v_mfma_f32_32x32x16_bf16 v[16:31], v[60:63], v[68:71], v[16:31]
    ds_read_b64_tr_b16 v[48:49], v11 offset:45056
    ds_read_b64_tr_b16 v[50:51], v11 offset:47104
    ds_read_b64_tr_b16 v[52:53], v13 offset:45056
    ds_read_b64_tr_b16 v[54:55], v13 offset:47104
    ds_read_b128 v[56:59], v9 offset:35840
    v_mfma_f32_32x32x16_bf16 v[32:47], v[64:67], v[68:71], v[32:47]
    s_waitcnt vmcnt(8) lgkmcnt(0)
    s_barrier
    v_mfma_f32_32x32x16_bf16 v[16:31], v[72:75], v[80:83], v[16:31]
    ds_read_b64_tr_b16 v[60:61], v10 offset:0
    ds_read_b64_tr_b16 v[62:63], v10 offset:2048
    ds_read_b64_tr_b16 v[64:65], v12 offset:0
    ds_read_b64_tr_b16 v[66:67], v12 offset:2048
    ds_read_b128 v[68:71], v8 offset:0
    s_add_u32 m0, s43, 0x18000
    s_nop 0
    buffer_load_dwordx4 v4, s[8:11], s41 offen offset:0 lds
    v_mfma_f32_32x32x16_bf16 v[32:47], v[76:79], v[80:83], v[32:47]
    buffer_load_dwordx4 v4, s[8:11], s41 offen offset:1024 lds
    s_add_u32 m0, s44, 0x18000
    s_nop 0
    s_waitcnt lgkmcnt(5)
    v_mfma_f32_32x32x16_bf16 v[16:31], v[48:51], v[56:59], v[16:31]
    ds_read_b64_tr_b16 v[72:73], v10 offset:4096
    ds_read_b64_tr_b16 v[74:75], v10 offset:6144
    ds_read_b64_tr_b16 v[76:77], v12 offset:4096
    ds_read_b64_tr_b16 v[78:79], v12 offset:6144
    ds_read_b128 v[80:83], v8 offset:1024
    buffer_load_dwordx4 v6, s[12:15], s42 offen lds
    s_add_u32 m0, s44, 0x18400
    s_nop 0
    v_mfma_f32_32x32x16_bf16 v[32:47], v[52:55], v[56:59], v[32:47]
    buffer_load_dwordx4 v7, s[12:15], s42 offen lds
    s_add_u32 s41, s41, 4096
    s_waitcnt lgkmcnt(5)
    v_mfma_f32_32x32x16_bf16 v[16:31], v[60:63], v[68:71], v[16:31]
    ds_read_b64_tr_b16 v[48:49], v10 offset:8192
    ds_read_b64_tr_b16 v[50:51], v10 offset:10240
    ds_read_b64_tr_b16 v[52:53], v12 offset:8192
    ds_read_b64_tr_b16 v[54:55], v12 offset:10240
    ds_read_b128 v[56:59], v8 offset:2048
    s_add_u32 s42, s42, 0x10000
    v_mfma_f32_32x32x16_bf16 v[32:47], v[64:67], v[68:71], v[32:47]
    s_waitcnt lgkmcnt(5)
    v_mfma_f32_32x32x16_bf16 v[16:31], v[72:75], v[80:83], v[16:31]
    ds_read_b64_tr_b16 v[60:61], v10 offset:12288
    ds_read_b64_tr_b16 v[62:63], v10 offset:14336
    ds_read_b64_tr_b16 v[64:65], v12 offset:12288
    ds_read_b64_tr_b16 v[66:67], v12 offset:14336
    ds_read_b128 v[68:71], v8 offset:3072
    v_mfma_f32_32x32x16_bf16 v[32:47], v[76:79], v[80:83], v[32:47]
    s_waitcnt vmcnt(8) lgkmcnt(0)
    s_barrier
    v_mfma_f32_32x32x16_bf16 v[16:31], v[48:51], v[56:59], v[16:31]
    ds_read_b64_tr_b16 v[72:73], v10 offset:32768
    ds_read_b64_tr_b16 v[74:75], v10 offset:34816
    ds_read_b64_tr_b16 v[76:77], v12 offset:32768
    ds_read_b64_tr_b16 v[78:79], v12 offset:34816
    ds_read_b128 v[80:83], v8 offset:32768
    s_add_u32 m0, s43, 0x0
    s_nop 0
    buffer_load_dwordx4 v4, s[8:11], s41 offen offset:0 lds
    v_mfma_f32_32x32x16_bf16 v[32:47], v[52:55], v[56:59], v[32:47]
    buffer_load_dwordx4 v4, s[8:11], s41 offen offset:1024 lds
    s_add_u32 m0, s44, 0x0
    s_nop 0
    s_waitcnt lgkmcnt(5)
    v_mfma_f32_32x32x16_bf16 v[16:31], v[60:63], v[68:71], v[16:31]
    ds_read_b64_tr_b16 v[48:49], v10 offset:36864
    ds_read_b64_tr_b16 v[50:51], v10 offset:38912
    ds_read_b64_tr_b16 v[52:53], v12 offset:36864
    ds_read_b64_tr_b16 v[54:55], v12 offset:38912
    ds_read_b128 v[56:59], v8 offset:33792
    buffer_load_dwordx4 v6, s[12:15], s42 offen lds
    s_add_u32 m0, s44, 0x400
    s_nop 0
    v_mfma_f32_32x32x16_bf16 v[32:47], v[64:67], v[68:71], v[32:47]
    buffer_load_dwordx4 v7, s[12:15], s42 offen lds
    s_add_u32 s41, s41, 4096
    s_waitcnt lgkmcnt(5)
    v_mfma_f32_32x32x16_bf16 v[16:31], v[72:75], v[80:83], v[16:31]
    ds_read_b64_tr_b16 v[60:61], v10 offset:40960
    ds_read_b64_tr_b16 v[62:63], v10 offset:43008
    ds_read_b64_tr_b16 v[64:65], v12 offset:40960
    ds_read_b64_tr_b16 v[66:67], v12 offset:43008
    ds_read_b128 v[68:71], v8 offset:34816
    s_add_u32 s42, s42, 0x10000
    v_mfma_f32_32x32x16_bf16 v[32:47], v[76:79], v[80:83], v[32:47]
    s_waitcnt lgkmcnt(5)
    v_mfma_f32_32x32x16_bf16 v[16:31], v[48:51], v[56:59], v[16:31]
    ds_read_b64_tr_b16 v[72:73], v10 offset:45056
    ds_read_b64_tr_b16 v[74:75], v10 offset:47104
    ds_read_b64_tr_b16 v[76:77], v12 offset:45056
    ds_read_b64_tr_b16 v[78:79], v12 offset:47104
    ds_read_b128 v[80:83], v8 offset:35840
    v_mfma_f32_32x32x16_bf16 v[32:47], v[52:55], v[56:59], v[32:47]
    s_waitcnt vmcnt(8) lgkmcnt(0)
    s_barrier
    v_mfma_f32_32x32x16_bf16 v[16:31], v[60:63], v[68:71], v[16:31]
    ds_read_b64_tr_b16 v[48:49], v11 offset:0
    ds_read_b64_tr_b16 v[50:51], v11 offset:2048
    ds_read_b64_tr_b16 v[52:53], v13 offset:0
    ds_read_b64_tr_b16 v[54:55], v13 offset:2048
    ds_read_b128 v[56:59], v9 offset:0
    s_add_u32 m0, s43, 0x8000
    s_nop 0
    buffer_load_dwordx4 v4, s[8:11], s41 offen offset:0 lds
    v_mfma_f32_32x32x16_bf16 v[32:47], v[64:67], v[68:71], v[32:47]
    buffer_load_dwordx4 v4, s[8:11], s41 offen offset:1024 lds
    s_add_u32 m0, s44, 0x8000
    s_nop 0
    s_waitcnt lgkmcnt(5)
    v_mfma_f32_32x32x16_bf16 v[16:31], v[72:75], v[80:83], v[16:31]
    ds_read_b64_tr_b16 v[60:61], v11 offset:4096
    ds_read_b64_tr_b16 v[62:63], v11 offset:6144
    ds_read_b64_tr_b16 v[64:65], v13 offset:4096
    ds_read_b64_tr_b16 v[66:67], v13 offset:6144
    ds_read_b128 v[68:71], v9 offset:1024
    buffer_load_dwordx4 v6, s[12:15], s42 offen lds
    s_add_u32 m0, s44, 0x8400
    s_nop 0
    v_mfma_f32_32x32x16_bf16 v[32:47], v[76:79], v[80:83], v[32:47]
    buffer_load_dwordx4 v7, s[12:15], s42 offen lds
    s_add_u32 s41, s41, 4096
    s_waitcnt lgkmcnt(5)
    v_mfma_f32_32x32x16_bf16 v[16:31], v[48:51], v[56:59], v[16:31]
    ds_read_b64_tr_b16 v[72:73], v11 offset:8192
    ds_read_b64_tr_b16 v[74:75], v11 offset:10240
    ds_read_b64_tr_b16 v[76:77], v13 offset:8192
    ds_read_b64_tr_b16 v[78:79], v13 offset:10240
    ds_read_b128 v[80:83], v9 offset:2048
    s_add_u32 s42, s42, 0x10000
    v_mfma_f32_32x32x16_bf16 v[32:47], v[52:55], v[56:59], v[32:47]
    s_waitcnt lgkmcnt(5)
    v_mfma_f32_32x32x16_bf16 v[16:31], v[60:63], v[68:71], v[16:31]
    ds_read_b64_tr_b16 v[48:49], v11 offset:12288
    ds_read_b64_tr_b16 v[50:51], v11 offset:14336
    ds_read_b64_tr_b16 v[52:53], v13 offset:12288
    ds_read_b64_tr_b16 v[54:55], v13 offset:14336
    ds_read_b128 v[56:59], v9 offset:3072
    v_mfma_f32_32x32x16_bf16 v[32:47], v[64:67], v[68:71], v[32:47]
    s_waitcnt vmcnt(8) lgkmcnt(0)
    s_barrier
    v_mfma_f32_32x32x16_bf16 v[16:31], v[72:75], v[80:83], v[16:31]
    ds_read_b64_tr_b16 v[60:61], v11 offset:32768
    ds_read_b64_tr_b16 v[62:63], v11 offset:34816
    ds_read_b64_tr_b16 v[64:65], v13 offset:32768
    ds_read_b64_tr_b16 v[66:67], v13 offset:34816
    ds_read_b128 v[68:71], v9 offset:32768
    s_add_u32 m0, s43, 0x10000
    s_nop 0
    buffer_load_dwordx4 v4, s[8:11], s41 offen offset:0 lds
    v_mfma_f32_32x32x16_bf16 v[32:47], v[76:79], v[80:83], v[32:47]
    buffer_load_dwordx4 v4, s[8:11], s41 offen offset:1024 lds
    s_add_u32 m0, s44, 0x10000
    s_nop 0
    s_waitcnt lgkmcnt(5)
    v_mfma_f32_32x32x16_bf16 v[16:31], v[48:51], v[56:59], v[16:31]
    ds_read_b64_tr_b16 v[72:73], v11 offset:36864
    ds_read_b64_tr_b16 v[74:75], v11 offset:38912
    ds_read_b64_tr_b16 v[76:77], v13 offset:36864
    ds_read_b64_tr_b16 v[78:79], v13 offset:38912
    ds_read_b128 v[80:83], v9 offset:33792
    buffer_load_dwordx4 v6, s[12:15], s42 offen lds
    s_add_u32 m0, s44, 0x10400
    s_nop 0
    v_mfma_f32_32x32x16_bf16 v[32:47], v[52:55], v[56:59], v[32:47]
    buffer_load_dwordx4 v7, s[12:15], s42 offen lds
    s_add_u32 s41, s41, 4096
    s_waitcnt lgkmcnt(5)
    v_mfma_f32_32x32x16_bf16 v[16:31], v[60:63], v[68:71], v[16:31]
    ds_read_b64_tr_b16 v[48:49], v11 offset:40960
    ds_read_b64_tr_b16 v[50:51], v11 offset:43008
    ds_read_b64_tr_b16 v[52:53], v13 offset:40960
    ds_read_b64_tr_b16 v[54:55], v13 offset:43008
    ds_read_b128 v[56:59], v9 offset:34816
    s_add_u32 s42, s42, 0x10000
    v_mfma_f32_32x32x16_bf16 v[32:47], v[64:67], v[68:71], v[32:47]
    s_waitcnt lgkmcnt(5)
    v_mfma_f32_32x32x16_bf16 v[16:31], v[72:75], v[80:83], v[16:31]
    ds_read_b64_tr_b16 v[60:61], v11 offset:45056
    ds_read_b64_tr_b16 v[62:63], v11 offset:47104
    ds_read_b64_tr_b16 v[64:65], v13 offset:45056
    ds_read_b64_tr_b16 v[66:67], v13 offset:47104
    ds_read_b128 v[68:71], v9 offset:35840
    v_mfma_f32_32x32x16_bf16 v[32:47], v[76:79], v[80:83], v[32:47]
    s_waitcnt vmcnt(8) lgkmcnt(0)
    s_barrier
    v_mfma_f32_32x32x16_bf16 v[16:31], v[48:51], v[56:59], v[16:31]
    ds_read_b64_tr_b16 v[72:73], v10 offset:0
    ds_read_b64_tr_b16 v[74:75], v10 offset:2048
    ds_read_b64_tr_b16 v[76:77], v12 offset:0
    ds_read_b64_tr_b16 v[78:79], v12 offset:2048
    ds_read_b128 v[80:83], v8 offset:0
    s_add_u32 m0, s43, 0x18000
    s_nop 0
    buffer_load_dwordx4 v4, s[8:11], s41 offen offset:0 lds
    v_mfma_f32_32x32x16_bf16 v[32:47], v[52:55], v[56:59], v[32:47]
    buffer_load_dwordx4 v4, s[8:11], s41 offen offset:1024 lds
    s_add_u32 m0, s44, 0x18000
    s_nop 0
    s_waitcnt lgkmcnt(5)
    v_mfma_f32_32x32x16_bf16 v[16:31], v[60:63], v[68:71], v[16:31]
    ds_read_b64_tr_b16 v[48:49], v10 offset:4096
    ds_read_b64_tr_b16 v[50:51], v10 offset:6144
    ds_read_b64_tr_b16 v[52:53], v12 offset:4096
    ds_read_b64_tr_b16 v[54:55], v12 offset:6144
    ds_read_b128 v[56:59], v8 offset:1024
    buffer_load_dwordx4 v6, s[12:15], s42 offen lds
    s_add_u32 m0, s44, 0x18400
    s_nop 0
    v_mfma_f32_32x32x16_bf16 v[32:47], v[64:67], v[68:71], v[32:47]
    buffer_load_dwordx4 v7, s[12:15], s42 offen lds
    s_add_u32 s41, s41, 4096
    s_waitcnt lgkmcnt(5)
    v_mfma_f32_32x32x16_bf16 v[16:31], v[72:75], v[80:83], v[16:31]
    ds_read_b64_tr_b16 v[60:61], v10 offset:8192
    ds_read_b64_tr_b16 v[62:63], v10 offset:10240
    ds_read_b64_tr_b16 v[64:65], v12 offset:8192
    ds_read_b64_tr_b16 v[66:67], v12 offset:10240
    ds_read_b128 v[68:71], v8 offset:2048
    s_add_u32 s42, s42, 0x10000
    v_mfma_f32_32x32x16_bf16 v[32:47], v[76:79], v[80:83], v[32:47]
    s_waitcnt lgkmcnt(5)
    v_mfma_f32_32x32x16_bf16 v[16:31], v[48:51], v[56:59], v[16:31]
    ds_read_b64_tr_b16 v[72:73], v10 offset:12288
    ds_read_b64_tr_b16 v[74:75], v10 offset:14336
    ds_read_b64_tr_b16 v[76:77], v12 offset:12288
    ds_read_b64_tr_b16 v[78:79], v12 offset:14336
    ds_read_b128 v[80:83], v8 offset:3072
    v_mfma_f32_32x32x16_bf16 v[32:47], v[52:55], v[56:59], v[32:47]
    s_waitcnt vmcnt(8) lgkmcnt(0)
    s_barrier
    v_mfma_f32_32x32x16_bf16 v[16:31], v[60:63], v[68:71], v[16:31]
    ds_read_b64_tr_b16 v[48:49], v10 offset:32768
    ds_read_b64_tr_b16 v[50:51], v10 offset:34816
    ds_read_b64_tr_b16 v[52:53], v12 offset:32768
    ds_read_b64_tr_b16 v[54:55], v12 offset:34816
    ds_read_b128 v[56:59], v8 offset:32768
    s_add_u32 m0, s43, 0x0
    s_nop 0
    buffer_load_dwordx4 v4, s[8:11], s41 offen offset:0 lds
    v_mfma_f32_32x32x16_bf16 v[32:47], v[64:67], v[68:71], v[32:47]
    buffer_load_dwordx4 v4, s[8:11], s41 offen offset:1024 lds
    s_add_u32 m0, s44, 0x0
    s_nop 0
    s_waitcnt lgkmcnt(5)
    v_mfma_f32_32x32x16_bf16 v[16:31], v[72:75], v[80:83], v[16:31]
    ds_read_b64_tr_b16 v[60:61], v10 offset:36864
    ds_read_b64_tr_b16 v[62:63], v10 offset:38912
    ds_read_b64_tr_b16 v[64:65], v12 offset:36864
    ds_read_b64_tr_b16 v[66:67], v12 offset:38912
    ds_read_b128 v[68:71], v8 offset:33792
    buffer_load_dwordx4 v6, s[12:15], s42 offen lds
    s_add_u32 m0, s44, 0x400
    s_nop 0
    v_mfma_f32_32x32x16_bf16 v[32:47], v[76:79], v[80:83], v[32:47]
    buffer_load_dwordx4 v7, s[12:15], s42 offen lds
    s_add_u32 s41, s41, 4096
    s_waitcnt lgkmcnt(5)
    v_mfma_f32_32x32x16_bf16 v[16:31], v[48:51], v[56:59], v[16:31]
    ds_read_b64_tr_b16 v[72:73], v10 offset:40960
    ds_read_b64_tr_b16 v[74:75], v10 offset:43008
    ds_read_b64_tr_b16 v[76:77], v12 offset:40960
    ds_read_b64_tr_b16 v[78:79], v12 offset:43008
    ds_read_b128 v[80:83], v8 offset:34816
    s_add_u32 s42, s42, 0x10000
    v_mfma_f32_32x32x16_bf16 v[32:47], v[52:55], v[56:59], v[32:47]
    s_waitcnt lgkmcnt(5)
    v_mfma_f32_32x32x16_bf16 v[16:31], v[60:63], v[68:71], v[16:31]
    ds_read_b64_tr_b16 v[48:49], v10 offset:45056
    ds_read_b64_tr_b16 v[50:51], v10 offset:47104
    ds_read_b64_tr_b16 v[52:53], v12 offset:45056
    ds_read_b64_tr_b16 v[54:55], v12 offset:47104
    ds_read_b128 v[56:59], v8 offset:35840
    v_mfma_f32_32x32x16_bf16 v[32:47], v[64:67], v[68:71], v[32:47]
    s_waitcnt vmcnt(8) lgkmcnt(0)
    s_barrier
    v_mfma_f32_32x32x16_bf16 v[16:31], v[72:75], v[80:83], v[16:31]
    ds_read_b64_tr_b16 v[60:61], v11 offset:0
    ds_read_b64_tr_b16 v[62:63], v11 offset:2048
    ds_read_b64_tr_b16 v[64:65], v13 offset:0
    ds_read_b64_tr_b16 v[66:67], v13 offset:2048
    ds_read_b128 v[68:71], v9 offset:0
    s_add_u32 m0, s43, 0x8000
    s_nop 0
    buffer_load_dwordx4 v4, s[8:11], s41 offen offset:0 lds
    v_mfma_f32_32x32x16_bf16 v[32:47], v[76:79], v[80:83], v[32:47]
    buffer_load_dwordx4 v4, s[8:11], s41 offen offset:1024 lds
    s_add_u32 m0, s44, 0x8000
    s_nop 0
    s_waitcnt lgkmcnt(5)
    v_mfma_f32_32x32x16_bf16 v[16:31], v[48:51], v[56:59], v[16:31]
    ds_read_b64_tr_b16 v[72:73], v11 offset:4096
    ds_read_b64_tr_b16 v[74:75], v11 offset:6144
    ds_read_b64_tr_b16 v[76:77], v13 offset:4096
    ds_read_b64_tr_b16 v[78:79], v13 offset:6144
    ds_read_b128 v[80:83], v9 offset:1024
    buffer_load_dwordx4 v6, s[12:15], s42 offen lds
    s_add_u32 m0, s44, 0x8400
    s_nop 0
    v_mfma_f32_32x32x16_bf16 v[32:47], v[52:55], v[56:59], v[32:47]
    buffer_load_dwordx4 v7, s[12:15], s42 offen lds
    s_add_u32 s41, s41, 4096
    s_waitcnt lgkmcnt(5)
    v_mfma_f32_32x32x16_bf16 v[16:31], v[60:63], v[68:71], v[16:31]
    ds_read_b64_tr_b16 v[48:49], v11 offset:8192
    ds_read_b64_tr_b16 v[50:51], v11 offset:10240
    ds_read_b64_tr_b16 v[52:53], v13 offset:8192
    ds_read_b64_tr_b16 v[54:55], v13 offset:10240
    ds_read_b128 v[56:59], v9 offset:2048
    s_add_u32 s42, s42, 0x10000
    v_mfma_f32_32x32x16_bf16 v[32:47], v[64:67], v[68:71], v[32:47]
    s_waitcnt lgkmcnt(5)
    v_mfma_f32_32x32x16_bf16 v[16:31], v[72:75], v[80:83], v[16:31]
    ds_read_b64_tr_b16 v[60:61], v11 offset:12288
    ds_read_b64_tr_b16 v[62:63], v11 offset:14336
    ds_read_b64_tr_b16 v[64:65], v13 offset:12288
    ds_read_b64_tr_b16 v[66:67], v13 offset:14336
    ds_read_b128 v[68:71], v9 offset:3072
    v_mfma_f32_32x32x16_bf16 v[32:47], v[76:79], v[80:83], v[32:47]
    s_waitcnt vmcnt(8) lgkmcnt(0)
    s_barrier
    v_mfma_f32_32x32x16_bf16 v[16:31], v[48:51], v[56:59], v[16:31]
    ds_read_b64_tr_b16 v[72:73], v11 offset:32768
    ds_read_b64_tr_b16 v[74:75], v11 offset:34816
    ds_read_b64_tr_b16 v[76:77], v13 offset:32768
    ds_read_b64_tr_b16 v[78:79], v13 offset:34816
    ds_read_b128 v[80:83], v9 offset:32768
    s_add_u32 m0, s43, 0x10000
    s_nop 0
    buffer_load_dwordx4 v4, s[8:11], s41 offen offset:0 lds
    v_mfma_f32_32x32x16_bf16 v[32:47], v[52:55], v[56:59], v[32:47]
    buffer_load_dwordx4 v4, s[8:11], s41 offen offset:1024 lds
    s_add_u32 m0, s44, 0x10000
    s_nop 0
    s_waitcnt lgkmcnt(5)
    v_mfma_f32_32x32x16_bf16 v[16:31], v[60:63], v[68:71], v[16:31]
    ds_read_b64_tr_b16 v[48:49], v11 offset:36864
    ds_read_b64_tr_b16 v[50:51], v11 offset:38912
    ds_read_b64_tr_b16 v[52:53], v13 offset:36864
    ds_read_b64_tr_b16 v[54:55], v13 offset:38912
    ds_read_b128 v[56:59], v9 offset:33792
    buffer_load_dwordx4 v6, s[12:15], s42 offen lds
    s_add_u32 m0, s44, 0x10400
    s_nop 0
    v_mfma_f32_32x32x16_bf16 v[32:47], v[64:67], v[68:71], v[32:47]
    buffer_load_dwordx4 v7, s[12:15], s42 offen lds
    s_add_u32 s41, s41, 4096
    s_waitcnt lgkmcnt(5)
    v_mfma_f32_32x32x16_bf16 v[16:31], v[72:75], v[80:83], v[16:31]
    ds_read_b64_tr_b16 v[60:61], v11 offset:40960
    ds_read_b64_tr_b16 v[62:63], v11 offset:43008
    ds_read_b64_tr_b16 v[64:65], v13 offset:40960
    ds_read_b64_tr_b16 v[66:67], v13 offset:43008
    ds_read_b128 v[68:71], v9 offset:34816
    s_add_u32 s42, s42, 0x10000
    v_mfma_f32_32x32x16_bf16 v[32:47], v[76:79], v[80:83], v[32:47]
    s_waitcnt lgkmcnt(5)
    v_mfma_f32_32x32x16_bf16 v[16:31], v[48:51], v[56:59], v[16:31]
    ds_read_b64_tr_b16 v[72:73], v11 offset:45056
    ds_read_b64_tr_b16 v[74:75], v11 offset:47104
    ds_read_b64_tr_b16 v[76:77], v13 offset:45056
    ds_read_b64_tr_b16 v[78:79], v13 offset:47104
    ds_read_b128 v[80:83], v9 offset:35840
    v_mfma_f32_32x32x16_bf16 v[32:47], v[52:55], v[56:59], v[32:47]
    s_waitcnt vmcnt(8) lgkmcnt(0)
    s_barrier
    v_mfma_f32_32x32x16_bf16 v[16:31], v[60:63], v[68:71], v[16:31]
    ds_read_b64_tr_b16 v[48:49], v10 offset:0
    ds_read_b64_tr_b16 v[50:51], v10 offset:2048
    ds_read_b64_tr_b16 v[52:53], v12 offset:0
    ds_read_b64_tr_b16 v[54:55], v12 offset:2048
    ds_read_b128 v[56:59], v8 offset:0
    s_add_u32 m0, s43, 0x18000
    s_nop 0
    buffer_load_dwordx4 v4, s[8:11], s41 offen offset:0 lds
    v_mfma_f32_32x32x16_bf16 v[32:47], v[64:67], v[68:71], v[32:47]
    buffer_load_dwordx4 v4, s[8:11], s41 offen offset:1024 lds
    s_add_u32 m0, s44, 0x18000
    s_nop 0
    s_waitcnt lgkmcnt(5)
    v_mfma_f32_32x32x16_bf16 v[16:31], v[72:75], v[80:83], v[16:31]
    ds_read_b64_tr_b16 v[60:61], v10 offset:4096
    ds_read_b64_tr_b16 v[62:63], v10 offset:6144
    ds_read_b64_tr_b16 v[64:65], v12 offset:4096
    ds_read_b64_tr_b16 v[66:67], v12 offset:6144
    ds_read_b128 v[68:71], v8 offset:1024
    buffer_load_dwordx4 v6, s[12:15], s42 offen lds
    s_add_u32 m0, s44, 0x18400
    s_nop 0
    v_mfma_f32_32x32x16_bf16 v[32:47], v[76:79], v[80:83], v[32:47]
    buffer_load_dwordx4 v7, s[12:15], s42 offen lds
    s_add_u32 s41, s41, 4096
    s_waitcnt lgkmcnt(5)
    v_mfma_f32_32x32x16_bf16 v[16:31], v[48:51], v[56:59], v[16:31]
    ds_read_b64_tr_b16 v[72:73], v10 offset:8192
    ds_read_b64_tr_b16 v[74:75], v10 offset:10240
    ds_read_b64_tr_b16 v[76:77], v12 offset:8192
    ds_read_b64_tr_b16 v[78:79], v12 offset:10240
    ds_read_b128 v[80:83], v8 offset:2048
    s_add_u32 s42, s42, 0x10000
    v_mfma_f32_32x32x16_bf16 v[32:47], v[52:55], v[56:59], v[32:47]
    s_waitcnt lgkmcnt(5)
    v_mfma_f32_32x32x16_bf16 v[16:31], v[60:63], v[68:71], v[16:31]
    ds_read_b64_tr_b16 v[48:49], v10 offset:12288
    ds_read_b64_tr_b16 v[50:51], v10 offset:14336
    ds_read_b64_tr_b16 v[52:53], v12 offset:12288
    ds_read_b64_tr_b16 v[54:55], v12 offset:14336
    ds_read_b128 v[56:59], v8 offset:3072
    v_mfma_f32_32x32x16_bf16 v[32:47], v[64:67], v[68:71], v[32:47]
    s_waitcnt vmcnt(8) lgkmcnt(0)
    s_barrier
    v_mfma_f32_32x32x16_bf16 v[16:31], v[72:75], v[80:83], v[16:31]
    ds_read_b64_tr_b16 v[60:61], v10 offset:32768
    ds_read_b64_tr_b16 v[62:63], v10 offset:34816
    ds_read_b64_tr_b16 v[64:65], v12 offset:32768
    ds_read_b64_tr_b16 v[66:67], v12 offset:34816
    ds_read_b128 v[68:71], v8 offset:32768
    v_mfma_f32_32x32x16_bf16 v[32:47], v[76:79], v[80:83], v[32:47]
    s_waitcnt lgkmcnt(5)
    v_mfma_f32_32x32x16_bf16 v[16:31], v[48:51], v[56:59], v[16:31]
    ds_read_b64_tr_b16 v[72:73], v10 offset:36864
    ds_read_b64_tr_b16 v[74:75], v10 offset:38912
    ds_read_b64_tr_b16 v[76:77], v12 offset:36864
    ds_read_b64_tr_b16 v[78:79], v12 offset:38912
    ds_read_b128 v[80:83], v8 offset:33792
    v_mfma_f32_32x32x16_bf16 v[32:47], v[52:55], v[56:59], v[32:47]
    s_waitcnt lgkmcnt(5)
    v_mfma_f32_32x32x16_bf16 v[16:31], v[60:63], v[68:71], v[16:31]
    ds_read_b64_tr_b16 v[48:49], v10 offset:40960
    ds_read_b64_tr_b16 v[50:51], v10 offset:43008
    ds_read_b64_tr_b16 v[52:53], v12 offset:40960
    ds_read_b64_tr_b16 v[54:55], v12 offset:43008
    ds_read_b128 v[56:59], v8 offset:34816
    v_mfma_f32_32x32x16_bf16 v[32:47], v[64:67], v[68:71], v[32:47]
    s_waitcnt lgkmcnt(5)
    v_mfma_f32_32x32x16_bf16 v[16:31], v[72:75], v[80:83], v[16:31]
    ds_read_b64_tr_b16 v[60:61], v10 offset:45056
    ds_read_b64_tr_b16 v[62:63], v10 offset:47104
    ds_read_b64_tr_b16 v[64:65], v12 offset:45056
    ds_read_b64_tr_b16 v[66:67], v12 offset:47104
    ds_read_b128 v[68:71], v8 offset:35840
    v_mfma_f32_32x32x16_bf16 v[32:47], v[76:79], v[80:83], v[32:47]
    s_waitcnt vmcnt(4) lgkmcnt(0)
    s_barrier
    v_mfma_f32_32x32x16_bf16 v[16:31], v[48:51], v[56:59], v[16:31]
    ds_read_b64_tr_b16 v[72:73], v11 offset:0
    ds_read_b64_tr_b16 v[74:75], v11 offset:2048
    ds_read_b64_tr_b16 v[76:77], v13 offset:0
    ds_read_b64_tr_b16 v[78:79], v13 offset:2048
    ds_read_b128 v[80:83], v9 offset:0
    v_mfma_f32_32x32x16_bf16 v[32:47], v[52:55], v[56:59], v[32:47]
    s_waitcnt lgkmcnt(5)
    v_mfma_f32_32x32x16_bf16 v[16:31], v[60:63], v[68:71], v[16:31]
    ds_read_b64_tr_b16 v[48:49], v11 offset:4096
    ds_read_b64_tr_b16 v[50:51], v11 offset:6144
    ds_read_b64_tr_b16 v[52:53], v13 offset:4096
    ds_read_b64_tr_b16 v[54:55], v13 offset:6144
    ds_read_b128 v[56:59], v9 offset:1024
    v_mfma_f32_32x32x16_bf16 v[32:47], v[64:67], v[68:71], v[32:47]
    s_waitcnt lgkmcnt(5)
    v_mfma_f32_32x32x16_bf16 v[16:31], v[72:75], v[80:83], v[16:31]
    ds_read_b64_tr_b16 v[60:61], v11 offset:8192
    ds_read_b64_tr_b16 v[62:63], v11 offset:10240
    ds_read_b64_tr_b16 v[64:65], v13 offset:8192
    ds_read_b64_tr_b16 v[66:67], v13 offset:10240
    ds_read_b128 v[68:71], v9 offset:2048
    v_mfma_f32_32x32x16_bf16 v[32:47], v[76:79], v[80:83], v[32:47]
    s_waitcnt lgkmcnt(5)
    v_mfma_f32_32x32x16_bf16 v[16:31], v[48:51], v[56:59], v[16:31]
    ds_read_b64_tr_b16 v[72:73], v11 offset:12288
    ds_read_b64_tr_b16 v[74:75], v11 offset:14336
    ds_read_b64_tr_b16 v[76:77], v13 offset:12288
    ds_read_b64_tr_b16 v[78:79], v13 offset:14336
    ds_read_b128 v[80:83], v9 offset:3072
    v_mfma_f32_32x32x16_bf16 v[32:47], v[52:55], v[56:59], v[32:47]
    s_waitcnt vmcnt(0) lgkmcnt(0)
    s_barrier
    v_mfma_f32_32x32x16_bf16 v[16:31], v[60:63], v[68:71], v[16:31]
    ds_read_b64_tr_b16 v[48:49], v11 offset:32768
    ds_read_b64_tr_b16 v[50:51], v11 offset:34816
    ds_read_b64_tr_b16 v[52:53], v13 offset:32768
    ds_read_b64_tr_b16 v[54:55], v13 offset:34816
    ds_read_b128 v[56:59], v9 offset:32768
    v_mfma_f32_32x32x16_bf16 v[32:47], v[64:67], v[68:71], v[32:47]
    s_waitcnt lgkmcnt(5)
    v_mfma_f32_32x32x16_bf16 v[16:31], v[72:75], v[80:83], v[16:31]
    ds_read_b64_tr_b16 v[60:61], v11 offset:36864
    ds_read_b64_tr_b16 v[62:63], v11 offset:38912
    ds_read_b64_tr_b16 v[64:65], v13 offset:36864
    ds_read_b64_tr_b16 v[66:67], v13 offset:38912
    ds_read_b128 v[68:71], v9 offset:33792
    v_mfma_f32_32x32x16_bf16 v[32:47], v[76:79], v[80:83], v[32:47]
    s_waitcnt lgkmcnt(5)
    v_mfma_f32_32x32x16_bf16 v[16:31], v[48:51], v[56:59], v[16:31]
    ds_read_b64_tr_b16 v[72:73], v11 offset:40960
    ds_read_b64_tr_b16 v[74:75], v11 offset:43008
    ds_read_b64_tr_b16 v[76:77], v13 offset:40960
    ds_read_b64_tr_b16 v[78:79], v13 offset:43008
    ds_read_b128 v[80:83], v9 offset:34816
    v_mfma_f32_32x32x16_bf16 v[32:47], v[52:55], v[56:59], v[32:47]
    s_waitcnt lgkmcnt(5)
    v_mfma_f32_32x32x16_bf16 v[16:31], v[60:63], v[68:71], v[16:31]
    ds_read_b64_tr_b16 v[48:49], v11 offset:45056
    ds_read_b64_tr_b16 v[50:51], v11 offset:47104
    ds_read_b64_tr_b16 v[52:53], v13 offset:45056
    ds_read_b64_tr_b16 v[54:55], v13 offset:47104
    ds_read_b128 v[56:59], v9 offset:35840
    v_mfma_f32_32x32x16_bf16 v[32:47], v[64:67], v[68:71], v[32:47]
    s_waitcnt lgkmcnt(5)
    v_mfma_f32_32x32x16_bf16 v[16:31], v[72:75], v[80:83], v[16:31]
    v_mfma_f32_32x32x16_bf16 v[32:47], v[76:79], v[80:83], v[32:47]
    s_waitcnt lgkmcnt(0)
    v_mfma_f32_32x32x16_bf16 v[16:31], v[48:51], v[56:59], v[16:31]
    v_mfma_f32_32x32x16_bf16 v[32:47], v[52:55], v[56:59], v[32:47]
    s_nop 11
    v_and_b32 v48, 31, v1
    v_lshlrev_b32 v48, 10, v48
    v_lshrrev_b32 v5, 5, v1
    v_lshl_add_u32 v48, v5, 4, v48
    s_lshl_b32 s45, s40, 21
    s_lshl_b32 s46, s36, 17
    s_add_u32 s45, s45, s46
    s_lshl_b32 s46, s39, 15
    s_add_u32 s45, s45, s46
    s_lshl_b32 s46, s37, 8
    s_add_u32 s45, s45, s46
    s_lshl_b32 s46, s38, 7
    s_add_u32 s45, s45, s46
    v_cvt_pk_bf16_f32 v60, v16, v17
    v_cvt_pk_bf16_f32 v61, v18, v19
    v_cvt_pk_bf16_f32 v62, v20, v21
    v_cvt_pk_bf16_f32 v63, v22, v23
    s_nop 1
    v_permlane32_swap_b32 v60, v62
    v_permlane32_swap_b32 v61, v63
    s_nop 1
    buffer_store_dwordx4 v[60:63], v48, s[20:23], s45 offen offset:0
    v_cvt_pk_bf16_f32 v72, v24, v25
    v_cvt_pk_bf16_f32 v73, v26, v27
    v_cvt_pk_bf16_f32 v74, v28, v29
    v_cvt_pk_bf16_f32 v75, v30, v31
    s_nop 1
    v_permlane32_swap_b32 v72, v74
    v_permlane32_swap_b32 v73, v75
    s_nop 1
    buffer_store_dwordx4 v[72:75], v48, s[20:23], s45 offen offset:32
    v_cvt_pk_bf16_f32 v60, v32, v33
    v_cvt_pk_bf16_f32 v61, v34, v35
    v_cvt_pk_bf16_f32 v62, v36, v37
    v_cvt_pk_bf16_f32 v63, v38, v39
    s_nop 1
    v_permlane32_swap_b32 v60, v62
    v_permlane32_swap_b32 v61, v63
    s_nop 1
    buffer_store_dwordx4 v[60:63], v48, s[20:23], s45 offen offset:64
    v_cvt_pk_bf16_f32 v72, v40, v41
    v_cvt_pk_bf16_f32 v73, v42, v43
    v_cvt_pk_bf16_f32 v74, v44, v45
    v_cvt_pk_bf16_f32 v75, v46, v47
    s_nop 1
    v_permlane32_swap_b32 v72, v74
    v_permlane32_swap_b32 v73, v75
    s_nop 1
    buffer_store_dwordx4 v[72:75], v48, s[20:23], s45 offen offset:96
.Loproj__end_1:
    s_endpgm
.globl red_kernel
.p2align 8
.type red_kernel,@function
red_kernel:
    s_cmp_ge_u32 s2, 512
    s_cbranch_scc1 .Lred_ke_end_1
    v_and_b32 v1, 63, v0
    v_lshrrev_b32 v2, 6, v0
    s_nop 0
    v_readfirstlane_b32 s3, v2
    s_load_dwordx2 s[8:9], s[0:1], 104
    s_load_dwordx2 s[12:13], s[0:1], 0
    s_load_dwordx2 s[16:17], s[0:1], 104
    s_load_dwordx2 s[20:21], s[0:1], 104
    s_waitcnt lgkmcnt(0)
    s_add_u32 s8, s8, 0x4200000
    s_addc_u32 s9, s9, 0
    s_and_b32 s9, s9, 0xffff
    s_mov_b32 s10, 0x1000000
    s_mov_b32 s11, 0x20000
    s_and_b32 s13, s13, 0xffff
    s_mov_b32 s14, 0x200000
    s_mov_b32 s15, 0x20000
    s_add_u32 s16, s16, 0x5200000
    s_addc_u32 s17, s17, 0
    s_and_b32 s17, s17, 0xffff
    s_mov_b32 s18, 0x200000
    s_mov_b32 s19, 0x20000
    s_add_u32 s20, s20, 0x5400000
    s_addc_u32 s21, s21, 0
    s_and_b32 s21, s21, 0xffff
    s_mov_b32 s22, 0x200000
    s_mov_b32 s23, 0x20000
    s_lshl_b32 s36, s2, 2
    s_add_u32 s36, s36, s3
    v_lshlrev_b32 v3, 4, v1
    s_lshl_b32 s38, s36, 10
    buffer_load_dwordx4 v[36:39], v3, s[12:15], s38 offen
    s_add_u32 s39, s38, 0
    buffer_load_dwordx4 v[52:55], v3, s[8:11], s39 offen
    s_add_u32 s39, s38, 2097152
    buffer_load_dwordx4 v[56:59], v3, s[8:11], s39 offen
    s_add_u32 s39, s38, 4194304
    buffer_load_dwordx4 v[60:63], v3, s[8:11], s39 offen
    s_add_u32 s39, s38, 6291456
    buffer_load_dwordx4 v[64:67], v3, s[8:11], s39 offen
    s_waitcnt vmcnt(0)
    v_lshlrev_b32 v40, 16, v36
    v_and_b32 v41, 0xffff0000, v36
    v_lshlrev_b32 v42, 16, v37
    v_and_b32 v43, 0xffff0000, v37
    v_lshlrev_b32 v44, 16, v38
    v_and_b32 v45, 0xffff0000, v38
    v_lshlrev_b32 v46, 16, v39
    v_and_b32 v47, 0xffff0000, v39
    v_lshlrev_b32 v4, 16, v52
    v_and_b32 v5, 0xffff0000, v52
    v_lshlrev_b32 v6, 16, v53
    v_and_b32 v7, 0xffff0000, v53
    v_lshlrev_b32 v8, 16, v54
    v_and_b32 v9, 0xffff0000, v54
    v_lshlrev_b32 v10, 16, v55
    v_and_b32 v11, 0xffff0000, v55
    v_lshlrev_b32 v12, 16, v56
    v_and_b32 v13, 0xffff0000, v56
    v_lshlrev_b32 v14, 16, v57
    v_and_b32 v15, 0xffff0000, v57
    v_lshlrev_b32 v16, 16, v58
    v_and_b32 v17, 0xffff0000, v58
    v_lshlrev_b32 v18, 16, v59
    v_and_b32 v19, 0xffff0000, v59
    v_lshlrev_b32 v20, 16, v60
    v_and_b32 v21, 0xffff0000, v60
    v_lshlrev_b32 v22, 16, v61
    v_and_b32 v23, 0xffff0000, v61
    v_lshlrev_b32 v24, 16, v62
    v_and_b32 v25, 0xffff0000, v62
    v_lshlrev_b32 v26, 16, v63
    v_and_b32 v27, 0xffff0000, v63
    v_lshlrev_b32 v28, 16, v64
    v_and_b32 v29, 0xffff0000, v64
    v_lshlrev_b32 v30, 16, v65
    v_and_b32 v31, 0xffff0000, v65
    v_lshlrev_b32 v32, 16, v66
    v_and_b32 v33, 0xffff0000, v66
    v_lshlrev_b32 v34, 16, v67
    v_and_b32 v35, 0xffff0000, v67
    v_add_f32 v4, v4, v12
    v_add_f32 v20, v20, v28
    v_add_f32 v4, v4, v20
    v_add_f32 v5, v5, v13
    v_add_f32 v21, v21, v29
    v_add_f32 v5, v5, v21
    v_add_f32 v6, v6, v14
    v_add_f32 v22, v22, v30
    v_add_f32 v6, v6, v22
    v_add_f32 v7, v7, v15
    v_add_f32 v23, v23, v31
    v_add_f32 v7, v7, v23
    v_add_f32 v8, v8, v16
    v_add_f32 v24, v24, v32
    v_add_f32 v8, v8, v24
    v_add_f32 v9, v9, v17
    v_add_f32 v25, v25, v33
    v_add_f32 v9, v9, v25
    v_add_f32 v10, v10, v18
    v_add_f32 v26, v26, v34
    v_add_f32 v10, v10, v26
    v_add_f32 v11, v11, v19
    v_add_f32 v27, v27, v35
    v_add_f32 v11, v11, v27
    v_cvt_pk_bf16_f32 v36, v4, v5
    v_cvt_pk_bf16_f32 v37, v6, v7
    v_cvt_pk_bf16_f32 v38, v8, v9
    v_cvt_pk_bf16_f32 v39, v10, v11
    v_lshlrev_b32 v4, 16, v36
    v_and_b32 v5, 0xffff0000, v36
    v_lshlrev_b32 v6, 16, v37
    v_and_b32 v7, 0xffff0000, v37
    v_lshlrev_b32 v8, 16, v38
    v_and_b32 v9, 0xffff0000, v38
    v_lshlrev_b32 v10, 16, v39
    v_and_b32 v11, 0xffff0000, v39
    v_add_f32 v40, v40, v4
    v_add_f32 v41, v41, v5
    v_add_f32 v42, v42, v6
    v_add_f32 v43, v43, v7
    v_add_f32 v44, v44, v8
    v_add_f32 v45, v45, v9
    v_add_f32 v46, v46, v10
    v_add_f32 v47, v47, v11
    v_cvt_pk_bf16_f32 v36, v40, v41
    v_cvt_pk_bf16_f32 v37, v42, v43
    v_cvt_pk_bf16_f32 v38, v44, v45
    v_cvt_pk_bf16_f32 v39, v46, v47
    buffer_store_dwordx4 v[36:39], v3, s[16:19], s38 offen
    v_lshlrev_b32 v40, 16, v36
    v_and_b32 v41, 0xffff0000, v36
    v_lshlrev_b32 v42, 16, v37
    v_and_b32 v43, 0xffff0000, v37
    v_lshlrev_b32 v44, 16, v38
    v_and_b32 v45, 0xffff0000, v38
    v_lshlrev_b32 v46, 16, v39
    v_and_b32 v47, 0xffff0000, v39
    v_add_f32 v48, v40, v41
    v_add_f32 v48, v48, v42
    v_add_f32 v48, v48, v43
    v_add_f32 v48, v48, v44
    v_add_f32 v48, v48, v45
    v_add_f32 v48, v48, v46
    v_add_f32 v48, v48, v47
    s_nop 1
    v_add_f32_dpp v48, v48, v48 quad_perm:[1,0,3,2] row_mask:0xf bank_mask:0xf
    s_nop 1
    v_add_f32_dpp v48, v48, v48 quad_perm:[2,3,0,1] row_mask:0xf bank_mask:0xf
    s_nop 1
    v_add_f32_dpp v48, v48, v48 row_half_mirror row_mask:0xf bank_mask:0xf
    s_nop 1
    v_add_f32_dpp v48, v48, v48 row_mirror row_mask:0xf bank_mask:0xf
    v_mov_b32 v50, v48
    s_nop 1
    v_permlane16_swap_b32 v48, v50
    s_nop 1
    v_add_f32 v48, v48, v50
    v_mov_b32 v50, v48
    s_nop 1
    v_permlane32_swap_b32 v48, v50
    s_nop 1
    v_add_f32 v48, v48, v50
    v_mul_f32 v48, 0x3b000000, v48
    v_sub_f32 v40, v40, v48
    v_sub_f32 v41, v41, v48
    v_sub_f32 v42, v42, v48
    v_sub_f32 v43, v43, v48
    v_sub_f32 v44, v44, v48
    v_sub_f32 v45, v45, v48
    v_sub_f32 v46, v46, v48
    v_sub_f32 v47, v47, v48
    v_mul_f32 v49, v40, v40
    v_fmac_f32 v49, v41, v41
    v_fmac_f32 v49, v42, v42
    v_fmac_f32 v49, v43, v43
    v_fmac_f32 v49, v44, v44
    v_fmac_f32 v49, v45, v45
    v_fmac_f32 v49, v46, v46
    v_fmac_f32 v49, v47, v47
    s_nop 1
    v_add_f32_dpp v49, v49, v49 quad_perm:[1,0,3,2] row_mask:0xf bank_mask:0xf
    s_nop 1
    v_add_f32_dpp v49, v49, v49 quad_perm:[2,3,0,1] row_mask:0xf bank_mask:0xf
    s_nop 1
    v_add_f32_dpp v49, v49, v49 row_half_mirror row_mask:0xf bank_mask:0xf
    s_nop 1
    v_add_f32_dpp v49, v49, v49 row_mirror row_mask:0xf bank_mask:0xf
    v_mov_b32 v50, v49
    s_nop 1
    v_permlane16_swap_b32 v49, v50
    s_nop 1
    v_add_f32 v49, v49, v50
    v_mov_b32 v50, v49
    s_nop 1
    v_permlane32_swap_b32 v49, v50
    s_nop 1
    v_add_f32 v49, v49, v50
    v_mov_b32 v50, 0x3727c5ac
    v_fmac_f32 v50, 0x3b000000, v49
    v_rsq_f32 v50, v50
    s_nop 0
    v_mul_f32 v40, v40, v50
    v_mul_f32 v41, v41, v50
    v_mul_f32 v42, v42, v50
    v_mul_f32 v43, v43, v50
    v_mul_f32 v44, v44, v50
    v_mul_f32 v45, v45, v50
    v_mul_f32 v46, v46, v50
    v_mul_f32 v47, v47, v50
    v_cvt_pk_bf16_f32 v4, v40, v41
    v_cvt_pk_bf16_f32 v5, v42, v43
    v_cvt_pk_bf16_f32 v6, v44, v45
    v_cvt_pk_bf16_f32 v7, v46, v47
    buffer_store_dwordx4 v[4:7], v3, s[20:23], s38 offen
.Lred_ke_end_1:
    s_endpgm
.globl mlpa_kernel
.p2align 8
.type mlpa_kernel,@function
mlpa_kernel:
    s_cmp_ge_u32 s2, 224
    s_cbranch_scc1 .Lmlpa_k_end_1
    v_and_b32 v1, 63, v0
    v_lshrrev_b32 v2, 6, v0
    s_nop 0
    v_readfirstlane_b32 s3, v2
    s_load_dwordx2 s[8:9], s[0:1], 104
    s_load_dwordx2 s[12:13], s[0:1], 56
    s_load_dwordx2 s[16:17], s[0:1], 64
    s_load_dwordx2 s[20:21], s[0:1], 104
    s_waitcnt lgkmcnt(0)
    s_add_u32 s8, s8, 0x5400000
    s_addc_u32 s9, s9, 0
    s_and_b32 s9, s9, 0xffff
    s_mov_b32 s10, 0x200000
    s_mov_b32 s11, 0x20000
    s_and_b32 s13, s13, 0xffff
    s_mov_b32 s14, 0x700000
    s_mov_b32 s15, 0x20000
    s_and_b32 s17, s17, 0xffff
    s_mov_b32 s18, 0xe00
    s_mov_b32 s19, 0x20000
    s_add_u32 s20, s20, 0x5600000
    s_addc_u32 s21, s21, 0
    s_and_b32 s21, s21, 0xffff
    s_mov_b32 s22, 0x200000
    s_mov_b32 s23, 0x20000
    s_and_b32 s36, s2, 7
    s_mul_i32 s36, s36, 28
    s_lshr_b32 s37, s2, 3
    s_add_u32 s36, s36, s37
    s_lshr_b32 s37, s36, 3
    s_and_b32 s36, s36, 7
    s_lshr_b32 s40, s3, 2
    s_bfe_u32 s38, s3, 0x10001
    s_and_b32 s39, s3, 1
    v_lshlrev_b32 v3, 4, v1
    v_lshl_add_u32 v4, v2, 1, 0
    v_lshrrev_b32 v7, 3, v1
    v_and_b32 v8, 7, v1
    v_mul_u32_u24 v9, 8, v4
    v_add_u32 v7, v7, v9
    v_bfe_u32 v9, v7, 1, 1
    v_lshlrev_b32 v9, 2, v9
    v_xor_b32 v8, v8, v9
    v_lshlrev_b32 v8, 4, v8
    s_mov_b32 s60, 3584
    v_mul_lo_u32 v5, s60, v7
    v_add_u32 v5, v5, v8
    v_lshl_add_u32 v4, v2, 1, 1
    v_lshrrev_b32 v7, 3, v1
    v_and_b32 v8, 7, v1
    v_mul_u32_u24 v9, 8, v4
    v_add_u32 v7, v7, v9
    v_bfe_u32 v9, v7, 1, 1
    v_lshlrev_b32 v9, 2, v9
    v_xor_b32 v8, v8, v9
    v_lshlrev_b32 v8, 4, v8
    s_mov_b32 s60, 3584
    v_mul_lo_u32 v6, s60, v7
    v_add_u32 v6, v6, v8
    s_lshl_b32 s42, s37, 7
    v_lshl_add_u32 v4, v2, 1, 0
    v_lshrrev_b32 v9, 3, v1
    v_and_b32 v10, 7, v1
    v_mul_u32_u24 v11, 8, v4
    v_add_u32 v9, v9, v11
    v_bfe_u32 v11, v9, 1, 1
    v_lshlrev_b32 v11, 2, v11
    v_xor_b32 v10, v10, v11
    v_lshlrev_b32 v10, 4, v10
    s_mov_b32 s60, 1024
    v_mul_lo_u32 v7, s60, v9
    v_add_u32 v7, v7, v10
    v_lshl_add_u32 v4, v2, 1, 1
    v_lshrrev_b32 v9, 3, v1
    v_and_b32 v10, 7, v1
    v_mul_u32_u24 v11, 8, v4
    v_add_u32 v9, v9, v11
    v_bfe_u32 v11, v9, 1, 1
    v_lshlrev_b32 v11, 2, v11
    v_xor_b32 v10, v10, v11
    v_lshlrev_b32 v10, 4, v10
    s_mov_b32 s60, 1024
    v_mul_lo_u32 v8, s60, v9
    v_add_u32 v8, v8, v10
    s_lshl_b32 s41, s36, 7
    s_lshl_b32 s43, s3, 11
    s_add_u32 s44, s43, 16384
    v_bfe_u32 v11, v1, 2, 2
    v_lshrrev_b32 v12, 5, v1
    v_lshlrev_b32 v12, 3, v12
    v_add_u32 v12, v12, v11
    v_mul_u32_u24 v9, 128, v12
    v_lshrrev_b32 v11, 1, v11
    v_xor_b32 v11, 0, v11
    v_lshlrev_b32 v11, 6, v11
    v_add_u32 v9, v9, v11
    v_bfe_u32 v11, v1, 4, 1
    v_lshlrev_b32 v11, 5, v11
    v_add_u32 v9, v9, v11
    v_and_b32 v11, 3, v1
    v_lshlrev_b32 v11, 3, v11
    v_add_u32 v9, v9, v11
    s_lshl_b32 s45, s38, 6
    v_xor_b32 v9, s45, v9
    s_lshl_b32 s45, s40, 13
    s_add_u32 s45, s45, 16384
    v_add_u32 v9, s45, v9
    v_add_u32 v10, 0x10000, v9
    v_bfe_u32 v13, v1, 2, 2
    v_lshrrev_b32 v14, 5, v1
    v_lshlrev_b32 v14, 3, v14
    v_add_u32 v14, v14, v13
    v_mul_u32_u24 v11, 128, v14
    v_lshrrev_b32 v13, 1, v13
    v_xor_b32 v13, 0, v13
    v_lshlrev_b32 v13, 6, v13
    v_add_u32 v11, v11, v13
    v_bfe_u32 v13, v1, 4, 1
    v_lshlrev_b32 v13, 5, v13
    v_add_u32 v11, v11, v13
    v_and_b32 v13, 3, v1
    v_lshlrev_b32 v13, 3, v13
    v_add_u32 v11, v11, v13
    s_lshl_b32 s45, s39, 6
    v_xor_b32 v11, s45, v11
    s_lshl_b32 s45, s40, 13
    v_add_u32 v11, s45, v11
    v_add_u32 v12, 0x10000, v11
    v_lshrrev_b32 v88, 5, v1
    v_and_b32 v89, 31, v1
    v_lshlrev_b32 v90, 3, v88
    s_lshl_b32 s45, s37, 7
    s_lshl_b32 s46, s38, 6
    s_add_u32 s45, s45, s46
    buffer_load_dwordx2 v[64:65], v90, s[16:19], s45 offen offset:0
    buffer_load_dwordx2 v[66:67], v90, s[16:19], s45 offen offset:16
    buffer_load_dwordx2 v[68:69], v90, s[16:19], s45 offen offset:32
    buffer_load_dwordx2 v[70:71], v90, s[16:19], s45 offen offset:48
    v_mov_b32 v16, 0
    v_mov_b32 v17, 0
    v_mov_b32 v18, 0
    v_mov_b32 v19, 0
    v_mov_b32 v20, 0
    v_mov_b32 v21, 0
    v_mov_b32 v22, 0
    v_mov_b32 v23, 0
    v_mov_b32 v24, 0
    v_mov_b32 v25, 0
    v_mov_b32 v26, 0
    v_mov_b32 v27, 0
    v_mov_b32 v28, 0
    v_mov_b32 v29, 0
    v_mov_b32 v30, 0
    v_mov_b32 v31, 0
    s_add_u32 m0, s43, 0x0
    s_nop 0
    buffer_load_dwordx4 v7, s[8:11], s41 offen lds
    s_add_u32 m0, s43, 0x400
    s_nop 0
    buffer_load_dwordx4 v8, s[8:11], s41 offen lds
    s_add_u32 m0, s44, 0x0
    s_nop 0
    buffer_load_dwordx4 v5, s[12:15], s42 offen lds
    s_add_u32 m0, s44, 0x400
    s_nop 0
    buffer_load_dwordx4 v6, s[12:15], s42 offen lds
    s_add_u32 s41, s41, 131072
    s_add_u32 s42, s42, 458752
    s_add_u32 m0, s43, 0x8000
    s_nop 0
    buffer_load_dwordx4 v7, s[8:11], s41 offen lds
    s_add_u32 m0, s43, 0x8400
    s_nop 0
    buffer_load_dwordx4 v8, s[8:11], s41 offen lds
    s_add_u32 m0, s44, 0x8000
    s_nop 0
    buffer_load_dwordx4 v5, s[12:15], s42 offen lds
    s_add_u32 m0, s44, 0x8400
    s_nop 0
    buffer_load_dwordx4 v6, s[12:15], s42 offen lds
    s_add_u32 s41, s41, 131072
    s_add_u32 s42, s42, 458752
    s_add_u32 m0, s43, 0x10000
    s_nop 0
    buffer_load_dwordx4 v7, s[8:11], s41 offen lds
    s_add_u32 m0, s43, 0x10400
    s_nop 0
    buffer_load_dwordx4 v8, s[8:11], s41 offen lds
    s_add_u32 m0, s44, 0x10000
    s_nop 0
    buffer_load_dwordx4 v5, s[12:15], s42 offen lds
    s_add_u32 m0, s44, 0x10400
    s_nop 0
    buffer_load_dwordx4 v6, s[12:15], s42 offen lds
    s_add_u32 s41, s41, 131072
    s_add_u32 s42, s42, 458752
    s_waitcnt vmcnt(8) lgkmcnt(0)
    s_barrier
    ds_read_b64_tr_b16 v[32:33], v9 offset:0
    ds_read_b64_tr_b16 v[34:35], v9 offset:512
    ds_read_b64_tr_b16 v[36:37], v11 offset:0
    ds_read_b64_tr_b16 v[38:39], v11 offset:512
    ds_read_b64_tr_b16 v[40:41], v9 offset:2048
    ds_read_b64_tr_b16 v[42:43], v9 offset:2560
    ds_read_b64_tr_b16 v[44:45], v11 offset:2048
    ds_read_b64_tr_b16 v[46:47], v11 offset:2560
    ds_read_b64_tr_b16 v[48:49], v9 offset:4096
    ds_read_b64_tr_b16 v[50:51], v9 offset:4608
    ds_read_b64_tr_b16 v[52:53], v11 offset:4096
    ds_read_b64_tr_b16 v[54:55], v11 offset:4608
    s_waitcnt lgkmcnt(8)
    v_mfma_f32_32x32x16_bf16 v[16:31], v[32:35], v[36:39], v[16:31]
    ds_read_b64_tr_b16 v[56:57], v9 offset:6144
    ds_read_b64_tr_b16 v[58:59], v9 offset:6656
    ds_read_b64_tr_b16 v[60:61], v11 offset:6144
    ds_read_b64_tr_b16 v[62:63], v11 offset:6656
    s_add_u32 m0, s43, 0x18000
    s_nop 0
    buffer_load_dwordx4 v7, s[8:11], s41 offen lds
    s_add_u32 m0, s43, 0x18400
    s_nop 0
    buffer_load_dwordx4 v8, s[8:11], s41 offen lds
    s_add_u32 m0, s44, 0x18000
    s_nop 0
    buffer_load_dwordx4 v5, s[12:15], s42 offen lds
    s_add_u32 m0, s44, 0x18400
    s_nop 0
    buffer_load_dwordx4 v6, s[12:15], s42 offen lds
    s_add_u32 s41, s41, 131072
    s_add_u32 s42, s42, 458752
    s_waitcnt vmcnt(8) lgkmcnt(0)
    s_barrier
    v_mfma_f32_32x32x16_bf16 v[16:31], v[40:43], v[44:47], v[16:31]
    ds_read_b64_tr_b16 v[32:33], v9 offset:32768
    ds_read_b64_tr_b16 v[34:35], v9 offset:33280
    ds_read_b64_tr_b16 v[36:37], v11 offset:32768
    ds_read_b64_tr_b16 v[38:39], v11 offset:33280
    s_add_u32 m0, s43, 0x0
    s_nop 0
    buffer_load_dwordx4 v7, s[8:11], s41 offen lds
    s_add_u32 m0, s43, 0x400
    s_nop 0
    buffer_load_dwordx4 v8, s[8:11], s41 offen lds
    s_add_u32 m0, s44, 0x0
    s_waitcnt lgkmcnt(8)
    v_mfma_f32_32x32x16_bf16 v[16:31], v[48:51], v[52:55], v[16:31]
    ds_read_b64_tr_b16 v[40:41], v9 offset:34816
    ds_read_b64_tr_b16 v[42:43], v9 offset:35328
    ds_read_b64_tr_b16 v[44:45], v11 offset:34816
    ds_read_b64_tr_b16 v[46:47], v11 offset:35328
    s_nop 0
    buffer_load_dwordx4 v5, s[12:15], s42 offen lds
    s_add_u32 m0, s44, 0x400
    s_nop 0
    buffer_load_dwordx4 v6, s[12:15], s42 offen lds
    s_add_u32 s41, s41, 131072
    s_waitcnt lgkmcnt(8)
    v_mfma_f32_32x32x16_bf16 v[16:31], v[56:59], v[60:63], v[16:31]
    ds_read_b64_tr_b16 v[48:49], v9 offset:36864
    ds_read_b64_tr_b16 v[50:51], v9 offset:37376
    ds_read_b64_tr_b16 v[52:53], v11 offset:36864
    ds_read_b64_tr_b16 v[54:55], v11 offset:37376
    s_add_u32 s42, s42, 458752
    s_waitcnt lgkmcnt(8)
    v_mfma_f32_32x32x16_bf16 v[16:31], v[32:35], v[36:39], v[16:31]
    ds_read_b64_tr_b16 v[56:57], v9 offset:38912
    ds_read_b64_tr_b16 v[58:59], v9 offset:39424
    ds_read_b64_tr_b16 v[60:61], v11 offset:38912
    ds_read_b64_tr_b16 v[62:63], v11 offset:39424
    s_waitcnt vmcnt(8) lgkmcnt(0)
    s_barrier
    v_mfma_f32_32x32x16_bf16 v[16:31], v[40:43], v[44:47], v[16:31]
    ds_read_b64_tr_b16 v[32:33], v10 offset:0
    ds_read_b64_tr_b16 v[34:35], v10 offset:512
    ds_read_b64_tr_b16 v[36:37], v12 offset:0
    ds_read_b64_tr_b16 v[38:39], v12 offset:512
    s_add_u32 m0, s43, 0x8000
    s_nop 0
    buffer_load_dwordx4 v7, s[8:11], s41 offen lds
    s_add_u32 m0, s43, 0x8400
    s_nop 0
    buffer_load_dwordx4 v8, s[8:11], s41 offen lds
    s_add_u32 m0, s44, 0x8000
    s_waitcnt lgkmcnt(8)
    v_mfma_f32_32x32x16_bf16 v[16:31], v[48:51], v[52:55], v[16:31]
    ds_read_b64_tr_b16 v[40:41], v10 offset:2048
    ds_read_b64_tr_b16 v[42:43], v10 offset:2560
    ds_read_b64_tr_b16 v[44:45], v12 offset:2048
    ds_read_b64_tr_b16 v[46:47], v12 offset:2560
    s_nop 0
    buffer_load_dwordx4 v5, s[12:15], s42 offen lds
    s_add_u32 m0, s44, 0x8400
    s_nop 0
    buffer_load_dwordx4 v6, s[12:15], s42 offen lds
    s_add_u32 s41, s41, 131072
    s_waitcnt lgkmcnt(8)
    v_mfma_f32_32x32x16_bf16 v[16:31], v[56:59], v[60:63], v[16:31]
    ds_read_b64_tr_b16 v[48:49], v10 offset:4096
    ds_read_b64_tr_b16 v[50:51], v10 offset:4608
    ds_read_b64_tr_b16 v[52:53], v12 offset:4096
    ds_read_b64_tr_b16 v[54:55], v12 offset:4608
    s_add_u32 s42, s42, 458752
    s_waitcnt lgkmcnt(8)
    v_mfma_f32_32x32x16_bf16 v[16:31], v[32:35], v[36:39], v[16:31]
    ds_read_b64_tr_b16 v[56:57], v10 offset:6144
    ds_read_b64_tr_b16 v[58:59], v10 offset:6656
    ds_read_b64_tr_b16 v[60:61], v12 offset:6144
    ds_read_b64_tr_b16 v[62:63], v12 offset:6656
    s_waitcnt vmcnt(8) lgkmcnt(0)
    s_barrier
    v_mfma_f32_32x32x16_bf16 v[16:31], v[40:43], v[44:47], v[16:31]
    ds_read_b64_tr_b16 v[32:33], v10 offset:32768
    ds_read_b64_tr_b16 v[34:35], v10 offset:33280
    ds_read_b64_tr_b16 v[36:37], v12 offset:32768
    ds_read_b64_tr_b16 v[38:39], v12 offset:33280
    s_add_u32 m0, s43, 0x10000
    s_nop 0
    buffer_load_dwordx4 v7, s[8:11], s41 offen lds
    s_add_u32 m0, s43, 0x10400
    s_nop 0
    buffer_load_dwordx4 v8, s[8:11], s41 offen lds
    s_add_u32 m0, s44, 0x10000
    s_waitcnt lgkmcnt(8)
    v_mfma_f32_32x32x16_bf16 v[16:31], v[48:51], v[52:55], v[16:31]
    ds_read_b64_tr_b16 v[40:41], v10 offset:34816
    ds_read_b64_tr_b16 v[42:43], v10 offset:35328
    ds_read_b64_tr_b16 v[44:45], v12 offset:34816
    ds_read_b64_tr_b16 v[46:47], v12 offset:35328
    s_nop 0
    buffer_load_dwordx4 v5, s[12:15], s42 offen lds
    s_add_u32 m0, s44, 0x10400
    s_nop 0
    buffer_load_dwordx4 v6, s[12:15], s42 offen lds
    s_add_u32 s41, s41, 131072
    s_waitcnt lgkmcnt(8)
    v_mfma_f32_32x32x16_bf16 v[16:31], v[56:59], v[60:63], v[16:31]
    ds_read_b64_tr_b16 v[48:49], v10 offset:36864
    ds_read_b64_tr_b16 v[50:51], v10 offset:37376
    ds_read_b64_tr_b16 v[52:53], v12 offset:36864
    ds_read_b64_tr_b16 v[54:55], v12 offset:37376
    s_add_u32 s42, s42, 458752
    s_waitcnt lgkmcnt(8)
    v_mfma_f32_32x32x16_bf16 v[16:31], v[32:35], v[36:39], v[16:31]
    ds_read_b64_tr_b16 v[56:57], v10 offset:38912
    ds_read_b64_tr_b16 v[58:59], v10 offset:39424
    ds_read_b64_tr_b16 v[60:61], v12 offset:38912
    ds_read_b64_tr_b16 v[62:63], v12 offset:39424
    s_waitcnt vmcnt(8) lgkmcnt(0)
    s_barrier
    v_mfma_f32_32x32x16_bf16 v[16:31], v[40:43], v[44:47], v[16:31]
    ds_read_b64_tr_b16 v[32:33], v9 offset:0
    ds_read_b64_tr_b16 v[34:35], v9 offset:512
    ds_read_b64_tr_b16 v[36:37], v11 offset:0
    ds_read_b64_tr_b16 v[38:39], v11 offset:512
    s_add_u32 m0, s43, 0x18000
    s_nop 0
    buffer_load_dwordx4 v7, s[8:11], s41 offen lds
    s_add_u32 m0, s43, 0x18400
    s_nop 0
    buffer_load_dwordx4 v8, s[8:11], s41 offen lds
    s_add_u32 m0, s44, 0x18000
    s_waitcnt lgkmcnt(8)
    v_mfma_f32_32x32x16_bf16 v[16:31], v[48:51], v[52:55], v[16:31]
    ds_read_b64_tr_b16 v[40:41], v9 offset:2048
    ds_read_b64_tr_b16 v[42:43], v9 offset:2560
    ds_read_b64_tr_b16 v[44:45], v11 offset:2048
    ds_read_b64_tr_b16 v[46:47], v11 offset:2560
    s_nop 0
    buffer_load_dwordx4 v5, s[12:15], s42 offen lds
    s_add_u32 m0, s44, 0x18400
    s_nop 0
    buffer_load_dwordx4 v6, s[12:15], s42 offen lds
    s_add_u32 s41, s41, 131072
    s_waitcnt lgkmcnt(8)
    v_mfma_f32_32x32x16_bf16 v[16:31], v[56:59], v[60:63], v[16:31]
    ds_read_b64_tr_b16 v[48:49], v9 offset:4096
    ds_read_b64_tr_b16 v[50:51], v9 offset:4608
    ds_read_b64_tr_b16 v[52:53], v11 offset:4096
    ds_read_b64_tr_b16 v[54:55], v11 offset:4608
    s_add_u32 s42, s42, 458752
    s_waitcnt lgkmcnt(8)
    v_mfma_f32_32x32x16_bf16 v[16:31], v[32:35], v[36:39], v[16:31]
    ds_read_b64_tr_b16 v[56:57], v9 offset:6144
    ds_read_b64_tr_b16 v[58:59], v9 offset:6656
    ds_read_b64_tr_b16 v[60:61], v11 offset:6144
    ds_read_b64_tr_b16 v[62:63], v11 offset:6656
    s_waitcnt vmcnt(8) lgkmcnt(0)
    s_barrier
    v_mfma_f32_32x32x16_bf16 v[16:31], v[40:43], v[44:47], v[16:31]
    ds_read_b64_tr_b16 v[32:33], v9 offset:32768
    ds_read_b64_tr_b16 v[34:35], v9 offset:33280
    ds_read_b64_tr_b16 v[36:37], v11 offset:32768
    ds_read_b64_tr_b16 v[38:39], v11 offset:33280
    s_add_u32 m0, s43, 0x0
    s_nop 0
    buffer_load_dwordx4 v7, s[8:11], s41 offen lds
    s_add_u32 m0, s43, 0x400
    s_nop 0
    buffer_load_dwordx4 v8, s[8:11], s41 offen lds
    s_add_u32 m0, s44, 0x0
    s_waitcnt lgkmcnt(8)
    v_mfma_f32_32x32x16_bf16 v[16:31], v[48:51], v[52:55], v[16:31]
    ds_read_b64_tr_b16 v[40:41], v9 offset:34816
    ds_read_b64_tr_b16 v[42:43], v9 offset:35328
    ds_read_b64_tr_b16 v[44:45], v11 offset:34816
    ds_read_b64_tr_b16 v[46:47], v11 offset:35328
    s_nop 0
    buffer_load_dwordx4 v5, s[12:15], s42 offen lds
    s_add_u32 m0, s44, 0x400
    s_nop 0
    buffer_load_dwordx4 v6, s[12:15], s42 offen lds
    s_add_u32 s41, s41, 131072
    s_waitcnt lgkmcnt(8)
    v_mfma_f32_32x32x16_bf16 v[16:31], v[56:59], v[60:63], v[16:31]
    ds_read_b64_tr_b16 v[48:49], v9 offset:36864
    ds_read_b64_tr_b16 v[50:51], v9 offset:37376
    ds_read_b64_tr_b16 v[52:53], v11 offset:36864
    ds_read_b64_tr_b16 v[54:55], v11 offset:37376
    s_add_u32 s42, s42, 458752
    s_waitcnt lgkmcnt(8)
    v_mfma_f32_32x32x16_bf16 v[16:31], v[32:35], v[36:39], v[16:31]
    ds_read_b64_tr_b16 v[56:57], v9 offset:38912
    ds_read_b64_tr_b16 v[58:59], v9 offset:39424
    ds_read_b64_tr_b16 v[60:61], v11 offset:38912
    ds_read_b64_tr_b16 v[62:63], v11 offset:39424
    s_waitcnt vmcnt(8) lgkmcnt(0)
    s_barrier
    v_mfma_f32_32x32x16_bf16 v[16:31], v[40:43], v[44:47], v[16:31]
    ds_read_b64_tr_b16 v[32:33], v10 offset:0
    ds_read_b64_tr_b16 v[34:35], v10 offset:512
    ds_read_b64_tr_b16 v[36:37], v12 offset:0
    ds_read_b64_tr_b16 v[38:39], v12 offset:512
    s_add_u32 m0, s43, 0x8000
    s_nop 0
    buffer_load_dwordx4 v7, s[8:11], s41 offen lds
    s_add_u32 m0, s43, 0x8400
    s_nop 0
    buffer_load_dwordx4 v8, s[8:11], s41 offen lds
    s_add_u32 m0, s44, 0x8000
    s_waitcnt lgkmcnt(8)
    v_mfma_f32_32x32x16_bf16 v[16:31], v[48:51], v[52:55], v[16:31]
    ds_read_b64_tr_b16 v[40:41], v10 offset:2048
    ds_read_b64_tr_b16 v[42:43], v10 offset:2560
    ds_read_b64_tr_b16 v[44:45], v12 offset:2048
    ds_read_b64_tr_b16 v[46:47], v12 offset:2560
    s_nop 0
    buffer_load_dwordx4 v5, s[12:15], s42 offen lds
    s_add_u32 m0, s44, 0x8400
    s_nop 0
    buffer_load_dwordx4 v6, s[12:15], s42 offen lds
    s_add_u32 s41, s41, 131072
    s_waitcnt lgkmcnt(8)
    v_mfma_f32_32x32x16_bf16 v[16:31], v[56:59], v[60:63], v[16:31]
    ds_read_b64_tr_b16 v[48:49], v10 offset:4096
    ds_read_b64_tr_b16 v[50:51], v10 offset:4608
    ds_read_b64_tr_b16 v[52:53], v12 offset:4096
    ds_read_b64_tr_b16 v[54:55], v12 offset:4608
    s_add_u32 s42, s42, 458752
    s_waitcnt lgkmcnt(8)
    v_mfma_f32_32x32x16_bf16 v[16:31], v[32:35], v[36:39], v[16:31]
    ds_read_b64_tr_b16 v[56:57], v10 offset:6144
    ds_read_b64_tr_b16 v[58:59], v10 offset:6656
    ds_read_b64_tr_b16 v[60:61], v12 offset:6144
    ds_read_b64_tr_b16 v[62:63], v12 offset:6656
    s_waitcnt vmcnt(8) lgkmcnt(0)
    s_barrier
    v_mfma_f32_32x32x16_bf16 v[16:31], v[40:43], v[44:47], v[16:31]
    ds_read_b64_tr_b16 v[32:33], v10 offset:32768
    ds_read_b64_tr_b16 v[34:35], v10 offset:33280
    ds_read_b64_tr_b16 v[36:37], v12 offset:32768
    ds_read_b64_tr_b16 v[38:39], v12 offset:33280
    s_add_u32 m0, s43, 0x10000
    s_nop 0
    buffer_load_dwordx4 v7, s[8:11], s41 offen lds
    s_add_u32 m0, s43, 0x10400
    s_nop 0
    buffer_load_dwordx4 v8, s[8:11], s41 offen lds
    s_add_u32 m0, s44, 0x10000
    s_waitcnt lgkmcnt(8)
    v_mfma_f32_32x32x16_bf16 v[16:31], v[48:51], v[52:55], v[16:31]
    ds_read_b64_tr_b16 v[40:41], v10 offset:34816
    ds_read_b64_tr_b16 v[42:43], v10 offset:35328
    ds_read_b64_tr_b16 v[44:45], v12 offset:34816
    ds_read_b64_tr_b16 v[46:47], v12 offset:35328
    s_nop 0
    buffer_load_dwordx4 v5, s[12:15], s42 offen lds
    s_add_u32 m0, s44, 0x10400
    s_nop 0
    buffer_load_dwordx4 v6, s[12:15], s42 offen lds
    s_add_u32 s41, s41, 131072
    s_waitcnt lgkmcnt(8)
    v_mfma_f32_32x32x16_bf16 v[16:31], v[56:59], v[60:63], v[16:31]
    ds_read_b64_tr_b16 v[48:49], v10 offset:36864
    ds_read_b64_tr_b16 v[50:51], v10 offset:37376
    ds_read_b64_tr_b16 v[52:53], v12 offset:36864
    ds_read_b64_tr_b16 v[54:55], v12 offset:37376
    s_add_u32 s42, s42, 458752
    s_waitcnt lgkmcnt(8)
    v_mfma_f32_32x32x16_bf16 v[16:31], v[32:35], v[36:39], v[16:31]
    ds_read_b64_tr_b16 v[56:57], v10 offset:38912
    ds_read_b64_tr_b16 v[58:59], v10 offset:39424
    ds_read_b64_tr_b16 v[60:61], v12 offset:38912
    ds_read_b64_tr_b16 v[62:63], v12 offset:39424
    s_waitcnt vmcnt(8) lgkmcnt(0)
    s_barrier
    v_mfma_f32_32x32x16_bf16 v[16:31], v[40:43], v[44:47], v[16:31]
    ds_read_b64_tr_b16 v[32:33], v9 offset:0
    ds_read_b64_tr_b16 v[34:35], v9 offset:512
    ds_read_b64_tr_b16 v[36:37], v11 offset:0
    ds_read_b64_tr_b16 v[38:39], v11 offset:512
    s_add_u32 m0, s43, 0x18000
    s_nop 0
    buffer_load_dwordx4 v7, s[8:11], s41 offen lds
    s_add_u32 m0, s43, 0x18400
    s_nop 0
    buffer_load_dwordx4 v8, s[8:11], s41 offen lds
    s_add_u32 m0, s44, 0x18000
    s_waitcnt lgkmcnt(8)
    v_mfma_f32_32x32x16_bf16 v[16:31], v[48:51], v[52:55], v[16:31]
    ds_read_b64_tr_b16 v[40:41], v9 offset:2048
    ds_read_b64_tr_b16 v[42:43], v9 offset:2560
    ds_read_b64_tr_b16 v[44:45], v11 offset:2048
    ds_read_b64_tr_b16 v[46:47], v11 offset:2560
    s_nop 0
    buffer_load_dwordx4 v5, s[12:15], s42 offen lds
    s_add_u32 m0, s44, 0x18400
    s_nop 0
    buffer_load_dwordx4 v6, s[12:15], s42 offen lds
    s_add_u32 s41, s41, 131072
    s_waitcnt lgkmcnt(8)
    v_mfma_f32_32x32x16_bf16 v[16:31], v[56:59], v[60:63], v[16:31]
    ds_read_b64_tr_b16 v[48:49], v9 offset:4096
    ds_read_b64_tr_b16 v[50:51], v9 offset:4608
    ds_read_b64_tr_b16 v[52:53], v11 offset:4096
    ds_read_b64_tr_b16 v[54:55], v11 offset:4608
    s_add_u32 s42, s42, 458752
    s_waitcnt lgkmcnt(8)
    v_mfma_f32_32x32x16_bf16 v[16:31], v[32:35], v[36:39], v[16:31]
    ds_read_b64_tr_b16 v[56:57], v9 offset:6144
    ds_read_b64_tr_b16 v[58:59], v9 offset:6656
    ds_read_b64_tr_b16 v[60:61], v11 offset:6144
    ds_read_b64_tr_b16 v[62:63], v11 offset:6656
    s_waitcnt vmcnt(8) lgkmcnt(0)
    s_barrier
    v_mfma_f32_32x32x16_bf16 v[16:31], v[40:43], v[44:47], v[16:31]
    ds_read_b64_tr_b16 v[32:33], v9 offset:32768
    ds_read_b64_tr_b16 v[34:35], v9 offset:33280
    ds_read_b64_tr_b16 v[36:37], v11 offset:32768
    ds_read_b64_tr_b16 v[38:39], v11 offset:33280
    s_add_u32 m0, s43, 0x0
    s_nop 0
    buffer_load_dwordx4 v7, s[8:11], s41 offen lds
    s_add_u32 m0, s43, 0x400
    s_nop 0
    buffer_load_dwordx4 v8, s[8:11], s41 offen lds
    s_add_u32 m0, s44, 0x0
    s_waitcnt lgkmcnt(8)
    v_mfma_f32_32x32x16_bf16 v[16:31], v[48:51], v[52:55], v[16:31]
    ds_read_b64_tr_b16 v[40:41], v9 offset:34816
    ds_read_b64_tr_b16 v[42:43], v9 offset:35328
    ds_read_b64_tr_b16 v[44:45], v11 offset:34816
    ds_read_b64_tr_b16 v[46:47], v11 offset:35328
    s_nop 0
    buffer_load_dwordx4 v5, s[12:15], s42 offen lds
    s_add_u32 m0, s44, 0x400
    s_nop 0
    buffer_load_dwordx4 v6, s[12:15], s42 offen lds
    s_add_u32 s41, s41, 131072
    s_waitcnt lgkmcnt(8)
    v_mfma_f32_32x32x16_bf16 v[16:31], v[56:59], v[60:63], v[16:31]
    ds_read_b64_tr_b16 v[48:49], v9 offset:36864
    ds_read_b64_tr_b16 v[50:51], v9 offset:37376
    ds_read_b64_tr_b16 v[52:53], v11 offset:36864
    ds_read_b64_tr_b16 v[54:55], v11 offset:37376
    s_add_u32 s42, s42, 458752
    s_waitcnt lgkmcnt(8)
    v_mfma_f32_32x32x16_bf16 v[16:31], v[32:35], v[36:39], v[16:31]
    ds_read_b64_tr_b16 v[56:57], v9 offset:38912
    ds_read_b64_tr_b16 v[58:59], v9 offset:39424
    ds_read_b64_tr_b16 v[60:61], v11 offset:38912
    ds_read_b64_tr_b16 v[62:63], v11 offset:39424
    s_waitcnt vmcnt(8) lgkmcnt(0)
    s_barrier
    v_mfma_f32_32x32x16_bf16 v[16:31], v[40:43], v[44:47], v[16:31]
    ds_read_b64_tr_b16 v[32:33], v10 offset:0
    ds_read_b64_tr_b16 v[34:35], v10 offset:512
    ds_read_b64_tr_b16 v[36:37], v12 offset:0
    ds_read_b64_tr_b16 v[38:39], v12 offset:512
    s_add_u32 m0, s43, 0x8000
    s_nop 0
    buffer_load_dwordx4 v7, s[8:11], s41 offen lds
    s_add_u32 m0, s43, 0x8400
    s_nop 0
    buffer_load_dwordx4 v8, s[8:11], s41 offen lds
    s_add_u32 m0, s44, 0x8000
    s_waitcnt lgkmcnt(8)
    v_mfma_f32_32x32x16_bf16 v[16:31], v[48:51], v[52:55], v[16:31]
    ds_read_b64_tr_b16 v[40:41], v10 offset:2048
    ds_read_b64_tr_b16 v[42:43], v10 offset:2560
    ds_read_b64_tr_b16 v[44:45], v12 offset:2048
    ds_read_b64_tr_b16 v[46:47], v12 offset:2560
    s_nop 0
    buffer_load_dwordx4 v5, s[12:15], s42 offen lds
    s_add_u32 m0, s44, 0x8400
    s_nop 0
    buffer_load_dwordx4 v6, s[12:15], s42 offen lds
    s_add_u32 s41, s41, 131072
    s_waitcnt lgkmcnt(8)
    v_mfma_f32_32x32x16_bf16 v[16:31], v[56:59], v[60:63], v[16:31]
    ds_read_b64_tr_b16 v[48:49], v10 offset:4096
    ds_read_b64_tr_b16 v[50:51], v10 offset:4608
    ds_read_b64_tr_b16 v[52:53], v12 offset:4096
    ds_read_b64_tr_b16 v[54:55], v12 offset:4608
    s_add_u32 s42, s42, 458752
    s_waitcnt lgkmcnt(8)
    v_mfma_f32_32x32x16_bf16 v[16:31], v[32:35], v[36:39], v[16:31]
    ds_read_b64_tr_b16 v[56:57], v10 offset:6144
    ds_read_b64_tr_b16 v[58:59], v10 offset:6656
    ds_read_b64_tr_b16 v[60:61], v12 offset:6144
    ds_read_b64_tr_b16 v[62:63], v12 offset:6656
    s_waitcnt vmcnt(8) lgkmcnt(0)
    s_barrier
    v_mfma_f32_32x32x16_bf16 v[16:31], v[40:43], v[44:47], v[16:31]
    ds_read_b64_tr_b16 v[32:33], v10 offset:32768
    ds_read_b64_tr_b16 v[34:35], v10 offset:33280
    ds_read_b64_tr_b16 v[36:37], v12 offset:32768
    ds_read_b64_tr_b16 v[38:39], v12 offset:33280
    s_add_u32 m0, s43, 0x10000
    s_nop 0
    buffer_load_dwordx4 v7, s[8:11], s41 offen lds
    s_add_u32 m0, s43, 0x10400
    s_nop 0
    buffer_load_dwordx4 v8, s[8:11], s41 offen lds
    s_add_u32 m0, s44, 0x10000
    s_waitcnt lgkmcnt(8)
    v_mfma_f32_32x32x16_bf16 v[16:31], v[48:51], v[52:55], v[16:31]
    ds_read_b64_tr_b16 v[40:41], v10 offset:34816
    ds_read_b64_tr_b16 v[42:43], v10 offset:35328
    ds_read_b64_tr_b16 v[44:45], v12 offset:34816
    ds_read_b64_tr_b16 v[46:47], v12 offset:35328
    s_nop 0
    buffer_load_dwordx4 v5, s[12:15], s42 offen lds
    s_add_u32 m0, s44, 0x10400
    s_nop 0
    buffer_load_dwordx4 v6, s[12:15], s42 offen lds
    s_add_u32 s41, s41, 131072
    s_waitcnt lgkmcnt(8)
    v_mfma_f32_32x32x16_bf16 v[16:31], v[56:59], v[60:63], v[16:31]
    ds_read_b64_tr_b16 v[48:49], v10 offset:36864
    ds_read_b64_tr_b16 v[50:51], v10 offset:37376
    ds_read_b64_tr_b16 v[52:53], v12 offset:36864
    ds_read_b64_tr_b16 v[54:55], v12 offset:37376
    s_add_u32 s42, s42, 458752
    s_waitcnt lgkmcnt(8)
    v_mfma_f32_32x32x16_bf16 v[16:31], v[32:35], v[36:39], v[16:31]
    ds_read_b64_tr_b16 v[56:57], v10 offset:38912
    ds_read_b64_tr_b16 v[58:59], v10 offset:39424
    ds_read_b64_tr_b16 v[60:61], v12 offset:38912
    ds_read_b64_tr_b16 v[62:63], v12 offset:39424
    s_waitcnt vmcnt(8) lgkmcnt(0)
    s_barrier
    v_mfma_f32_32x32x16_bf16 v[16:31], v[40:43], v[44:47], v[16:31]
    ds_read_b64_tr_b16 v[32:33], v9 offset:0
    ds_read_b64_tr_b16 v[34:35], v9 offset:512
    ds_read_b64_tr_b16 v[36:37], v11 offset:0
    ds_read_b64_tr_b16 v[38:39], v11 offset:512
    s_add_u32 m0, s43, 0x18000
    s_nop 0
    buffer_load_dwordx4 v7, s[8:11], s41 offen lds
    s_add_u32 m0, s43, 0x18400
    s_nop 0
    buffer_load_dwordx4 v8, s[8:11], s41 offen lds
    s_add_u32 m0, s44, 0x18000
    s_waitcnt lgkmcnt(8)
    v_mfma_f32_32x32x16_bf16 v[16:31], v[48:51], v[52:55], v[16:31]
    ds_read_b64_tr_b16 v[40:41], v9 offset:2048
    ds_read_b64_tr_b16 v[42:43], v9 offset:2560
    ds_read_b64_tr_b16 v[44:45], v11 offset:2048
    ds_read_b64_tr_b16 v[46:47], v11 offset:2560
    s_nop 0
    buffer_load_dwordx4 v5, s[12:15], s42 offen lds
    s_add_u32 m0, s44, 0x18400
    s_nop 0
    buffer_load_dwordx4 v6, s[12:15], s42 offen lds
    s_add_u32 s41, s41, 131072
    s_waitcnt lgkmcnt(8)
    v_mfma_f32_32x32x16_bf16 v[16:31], v[56:59], v[60:63], v[16:31]
    ds_read_b64_tr_b16 v[48:49], v9 offset:4096
    ds_read_b64_tr_b16 v[50:51], v9 offset:4608
    ds_read_b64_tr_b16 v[52:53], v11 offset:4096
    ds_read_b64_tr_b16 v[54:55], v11 offset:4608
    s_add_u32 s42, s42, 458752
    s_waitcnt lgkmcnt(8)
    v_mfma_f32_32x32x16_bf16 v[16:31], v[32:35], v[36:39], v[16:31]
    ds_read_b64_tr_b16 v[56:57], v9 offset:6144
    ds_read_b64_tr_b16 v[58:59], v9 offset:6656
    ds_read_b64_tr_b16 v[60:61], v11 offset:6144
    ds_read_b64_tr_b16 v[62:63], v11 offset:6656
    s_waitcnt vmcnt(8) lgkmcnt(0)
    s_barrier
    v_mfma_f32_32x32x16_bf16 v[16:31], v[40:43], v[44:47], v[16:31]
    ds_read_b64_tr_b16 v[32:33], v9 offset:32768
    ds_read_b64_tr_b16 v[34:35], v9 offset:33280
    ds_read_b64_tr_b16 v[36:37], v11 offset:32768
    ds_read_b64_tr_b16 v[38:39], v11 offset:33280
    s_waitcnt lgkmcnt(8)
    v_mfma_f32_32x32x16_bf16 v[16:31], v[48:51], v[52:55], v[16:31]
    ds_read_b64_tr_b16 v[40:41], v9 offset:34816
    ds_read_b64_tr_b16 v[42:43], v9 offset:35328
    ds_read_b64_tr_b16 v[44:45], v11 offset:34816
    ds_read_b64_tr_b16 v[46:47], v11 offset:35328
    s_waitcnt lgkmcnt(8)
    v_mfma_f32_32x32x16_bf16 v[16:31], v[56:59], v[60:63], v[16:31]
    ds_read_b64_tr_b16 v[48:49], v9 offset:36864
    ds_read_b64_tr_b16 v[50:51], v9 offset:37376
    ds_read_b64_tr_b16 v[52:53], v11 offset:36864
    ds_read_b64_tr_b16 v[54:55], v11 offset:37376
    s_waitcnt lgkmcnt(8)
    v_mfma_f32_32x32x16_bf16 v[16:31], v[32:35], v[36:39], v[16:31]
    ds_read_b64_tr_b16 v[56:57], v9 offset:38912
    ds_read_b64_tr_b16 v[58:59], v9 offset:39424
    ds_read_b64_tr_b16 v[60:61], v11 offset:38912
    ds_read_b64_tr_b16 v[62:63], v11 offset:39424
    s_waitcnt vmcnt(4) lgkmcnt(0)
    s_barrier
    v_mfma_f32_32x32x16_bf16 v[16:31], v[40:43], v[44:47], v[16:31]
    ds_read_b64_tr_b16 v[32:33], v10 offset:0
    ds_read_b64_tr_b16 v[34:35], v10 offset:512
    ds_read_b64_tr_b16 v[36:37], v12 offset:0
    ds_read_b64_tr_b16 v[38:39], v12 offset:512
    s_waitcnt lgkmcnt(8)
    v_mfma_f32_32x32x16_bf16 v[16:31], v[48:51], v[52:55], v[16:31]
    ds_read_b64_tr_b16 v[40:41], v10 offset:2048
    ds_read_b64_tr_b16 v[42:43], v10 offset:2560
    ds_read_b64_tr_b16 v[44:45], v12 offset:2048
    ds_read_b64_tr_b16 v[46:47], v12 offset:2560
    s_waitcnt lgkmcnt(8)
    v_mfma_f32_32x32x16_bf16 v[16:31], v[56:59], v[60:63], v[16:31]
    ds_read_b64_tr_b16 v[48:49], v10 offset:4096
    ds_read_b64_tr_b16 v[50:51], v10 offset:4608
    ds_read_b64_tr_b16 v[52:53], v12 offset:4096
    ds_read_b64_tr_b16 v[54:55], v12 offset:4608
    s_waitcnt lgkmcnt(8)
    v_mfma_f32_32x32x16_bf16 v[16:31], v[32:35], v[36:39], v[16:31]
    ds_read_b64_tr_b16 v[56:57], v10 offset:6144
    ds_read_b64_tr_b16 v[58:59], v10 offset:6656
    ds_read_b64_tr_b16 v[60:61], v12 offset:6144
    ds_read_b64_tr_b16 v[62:63], v12 offset:6656
    s_waitcnt vmcnt(0) lgkmcnt(0)
    s_barrier
    v_mfma_f32_32x32x16_bf16 v[16:31], v[40:43], v[44:47], v[16:31]
    ds_read_b64_tr_b16 v[32:33], v10 offset:32768
    ds_read_b64_tr_b16 v[34:35], v10 offset:33280
    ds_read_b64_tr_b16 v[36:37], v12 offset:32768
    ds_read_b64_tr_b16 v[38:39], v12 offset:33280
    s_waitcnt lgkmcnt(8)
    v_mfma_f32_32x32x16_bf16 v[16:31], v[48:51], v[52:55], v[16:31]
    ds_read_b64_tr_b16 v[40:41], v10 offset:34816
    ds_read_b64_tr_b16 v[42:43], v10 offset:35328
    ds_read_b64_tr_b16 v[44:45], v12 offset:34816
    ds_read_b64_tr_b16 v[46:47], v12 offset:35328
    s_waitcnt lgkmcnt(8)
    v_mfma_f32_32x32x16_bf16 v[16:31], v[56:59], v[60:63], v[16:31]
    ds_read_b64_tr_b16 v[48:49], v10 offset:36864
    ds_read_b64_tr_b16 v[50:51], v10 offset:37376
    ds_read_b64_tr_b16 v[52:53], v12 offset:36864
    ds_read_b64_tr_b16 v[54:55], v12 offset:37376
    s_waitcnt lgkmcnt(8)
    v_mfma_f32_32x32x16_bf16 v[16:31], v[32:35], v[36:39], v[16:31]
    ds_read_b64_tr_b16 v[56:57], v10 offset:38912
    ds_read_b64_tr_b16 v[58:59], v10 offset:39424
    ds_read_b64_tr_b16 v[60:61], v12 offset:38912
    ds_read_b64_tr_b16 v[62:63], v12 offset:39424
    s_waitcnt lgkmcnt(8)
    v_mfma_f32_32x32x16_bf16 v[16:31], v[40:43], v[44:47], v[16:31]
    s_waitcnt lgkmcnt(4)
    v_mfma_f32_32x32x16_bf16 v[16:31], v[48:51], v[52:55], v[16:31]
    s_waitcnt lgkmcnt(0)
    v_mfma_f32_32x32x16_bf16 v[16:31], v[56:59], v[60:63], v[16:31]
    s_nop 11
    s_and_b32 s45, s3, 3
    s_lshl_b32 s45, s45, 12
    s_add_u32 s45, s45, 32768
    v_add_u32 v32, s45, v3
    s_cmp_eq_u32 s40, 0
    s_cbranch_scc1 .Lmlpa_k_ks0_3
    ds_write_b128 v32, v[16:19] offset:0
    ds_write_b128 v32, v[20:23] offset:1024
    ds_write_b128 v32, v[24:27] offset:2048
    ds_write_b128 v32, v[28:31] offset:3072
    s_waitcnt lgkmcnt(0)
    s_barrier
    s_branch .Lmlpa_k_end_1
.Lmlpa_k_ks0_3:
    s_barrier
    ds_read_b128 v[40:43], v32 offset:0
    ds_read_b128 v[44:47], v32 offset:1024
    ds_read_b128 v[48:51], v32 offset:2048
    ds_read_b128 v[52:55], v32 offset:3072
    s_waitcnt lgkmcnt(0)
    v_add_f32 v16, v16, v40
    v_add_f32 v17, v17, v41
    v_add_f32 v18, v18, v42
    v_add_f32 v19, v19, v43
    v_add_f32 v20, v20, v44
    v_add_f32 v21, v21, v45
    v_add_f32 v22, v22, v46
    v_add_f32 v23, v23, v47
    v_add_f32 v24, v24, v48
    v_add_f32 v25, v25, v49
    v_add_f32 v26, v26, v50
    v_add_f32 v27, v27, v51
    v_add_f32 v28, v28, v52
    v_add_f32 v29, v29, v53
    v_add_f32 v30, v30, v54
    v_add_f32 v31, v31, v55
    v_lshlrev_b32 v72, 16, v64
    v_and_b32 v73, 0xffff0000, v64
    v_lshlrev_b32 v74, 16, v65
    v_and_b32 v75, 0xffff0000, v65
    v_lshlrev_b32 v76, 16, v66
    v_and_b32 v77, 0xffff0000, v66
    v_lshlrev_b32 v78, 16, v67
    v_and_b32 v79, 0xffff0000, v67
    v_lshlrev_b32 v80, 16, v68
    v_and_b32 v81, 0xffff0000, v68
    v_lshlrev_b32 v82, 16, v69
    v_and_b32 v83, 0xffff0000, v69
    v_lshlrev_b32 v84, 16, v70
    v_and_b32 v85, 0xffff0000, v70
    v_lshlrev_b32 v86, 16, v71
    v_and_b32 v87, 0xffff0000, v71
    s_mov_b32 s45, 0xc0135761
    s_mov_b32 s46, 0xbdd2d3e8
    v_add_f32 v16, v16, v72
    v_mul_f32 v40, v16, v16
    v_mov_b32 v72, s45
    v_fmac_f32 v72, s46, v40
    v_mul_f32 v40, v16, v72
    v_add_f32 v17, v17, v73
    v_mul_f32 v41, v17, v17
    v_mov_b32 v73, s45
    v_fmac_f32 v73, s46, v41
    v_mul_f32 v41, v17, v73
    v_add_f32 v18, v18, v74
    v_mul_f32 v42, v18, v18
    v_mov_b32 v74, s45
    v_fmac_f32 v74, s46, v42
    v_mul_f32 v42, v18, v74
    v_add_f32 v19, v19, v75
    v_mul_f32 v43, v19, v19
    v_mov_b32 v75, s45
    v_fmac_f32 v75, s46, v43
    v_mul_f32 v43, v19, v75
    v_add_f32 v20, v20, v76
    v_mul_f32 v44, v20, v20
    v_mov_b32 v76, s45
    v_fmac_f32 v76, s46, v44
    v_mul_f32 v44, v20, v76
    v_add_f32 v21, v21, v77
    v_mul_f32 v45, v21, v21
    v_mov_b32 v77, s45
    v_fmac_f32 v77, s46, v45
    v_mul_f32 v45, v21, v77
    v_add_f32 v22, v22, v78
    v_mul_f32 v46, v22, v22
    v_mov_b32 v78, s45
    v_fmac_f32 v78, s46, v46
    v_mul_f32 v46, v22, v78
    v_add_f32 v23, v23, v79
    v_mul_f32 v47, v23, v23
    v_mov_b32 v79, s45
    v_fmac_f32 v79, s46, v47
    v_mul_f32 v47, v23, v79
    v_add_f32 v24, v24, v80
    v_mul_f32 v48, v24, v24
    v_mov_b32 v80, s45
    v_fmac_f32 v80, s46, v48
    v_mul_f32 v48, v24, v80
    v_add_f32 v25, v25, v81
    v_mul_f32 v49, v25, v25
    v_mov_b32 v81, s45
    v_fmac_f32 v81, s46, v49
    v_mul_f32 v49, v25, v81
    v_add_f32 v26, v26, v82
    v_mul_f32 v50, v26, v26
    v_mov_b32 v82, s45
    v_fmac_f32 v82, s46, v50
    v_mul_f32 v50, v26, v82
    v_add_f32 v27, v27, v83
    v_mul_f32 v51, v27, v27
    v_mov_b32 v83, s45
    v_fmac_f32 v83, s46, v51
    v_mul_f32 v51, v27, v83
    v_add_f32 v28, v28, v84
    v_mul_f32 v52, v28, v28
    v_mov_b32 v84, s45
    v_fmac_f32 v84, s46, v52
    v_mul_f32 v52, v28, v84
    v_add_f32 v29, v29, v85
    v_mul_f32 v53, v29, v29
    v_mov_b32 v85, s45
    v_fmac_f32 v85, s46, v53
    v_mul_f32 v53, v29, v85
    v_add_f32 v30, v30, v86
    v_mul_f32 v54, v30, v30
    v_mov_b32 v86, s45
    v_fmac_f32 v86, s46, v54
    v_mul_f32 v54, v30, v86
    v_add_f32 v31, v31, v87
    v_mul_f32 v55, v31, v31
    v_mov_b32 v87, s45
    v_fmac_f32 v87, s46, v55
    v_mul_f32 v55, v31, v87
    v_exp_f32 v40, v40
    v_exp_f32 v41, v41
    v_exp_f32 v42, v42
    v_exp_f32 v43, v43
    v_exp_f32 v44, v44
    v_exp_f32 v45, v45
    v_exp_f32 v46, v46
    v_exp_f32 v47, v47
    v_exp_f32 v48, v48
    v_exp_f32 v49, v49
    v_exp_f32 v50, v50
    v_exp_f32 v51, v51
    v_exp_f32 v52, v52
    v_exp_f32 v53, v53
    v_exp_f32 v54, v54
    v_exp_f32 v55, v55
    v_add_f32 v40, 1.0, v40
    v_add_f32 v41, 1.0, v41
    v_add_f32 v42, 1.0, v42
    v_add_f32 v43, 1.0, v43
    v_add_f32 v44, 1.0, v44
    v_add_f32 v45, 1.0, v45
    v_add_f32 v46, 1.0, v46
    v_add_f32 v47, 1.0, v47
    v_add_f32 v48, 1.0, v48
    v_add_f32 v49, 1.0, v49
    v_add_f32 v50, 1.0, v50
    v_add_f32 v51, 1.0, v51
    v_add_f32 v52, 1.0, v52
    v_add_f32 v53, 1.0, v53
    v_add_f32 v54, 1.0, v54
    v_add_f32 v55, 1.0, v55
    v_rcp_f32 v40, v40
    v_rcp_f32 v41, v41
    v_rcp_f32 v42, v42
    v_rcp_f32 v43, v43
    v_rcp_f32 v44, v44
    v_rcp_f32 v45, v45
    v_rcp_f32 v46, v46
    v_rcp_f32 v47, v47
    v_rcp_f32 v48, v48
    v_rcp_f32 v49, v49
    v_rcp_f32 v50, v50
    v_rcp_f32 v51, v51
    v_rcp_f32 v52, v52
    v_rcp_f32 v53, v53
    v_rcp_f32 v54, v54
    v_rcp_f32 v55, v55
    v_mul_f32 v16, v16, v40
    v_mul_f32 v17, v17, v41
    v_mul_f32 v18, v18, v42
    v_mul_f32 v19, v19, v43
    v_mul_f32 v20, v20, v44
    v_mul_f32 v21, v21, v45
    v_mul_f32 v22, v22, v46
    v_mul_f32 v23, v23, v47
    v_mul_f32 v24, v24, v48
    v_mul_f32 v25, v25, v49
    v_mul_f32 v26, v26, v50
    v_mul_f32 v27, v27, v51
    v_mul_f32 v28, v28, v52
    v_mul_f32 v29, v29, v53
    v_mul_f32 v30, v30, v54
    v_mul_f32 v31, v31, v55
    s_lshl_b32 s45, s36, 1
    s_add_u32 s45, s45, s39
    s_mul_i32 s45, s45, 112
    s_lshl_b32 s46, s37, 2
    s_add_u32 s45, s45, s46
    s_lshl_b32 s46, s38, 1
    s_add_u32 s45, s45, s46
    s_lshl_b32 s45, s45, 10
    v_cvt_pk_bf16_f32 v40, v16, v17
    v_cvt_pk_bf16_f32 v41, v18, v19
    v_cvt_pk_bf16_f32 v42, v20, v21
    v_cvt_pk_bf16_f32 v43, v22, v23
    buffer_store_dwordx4 v[40:43], v3, s[20:23], s45 offen offset:0
    v_cvt_pk_bf16_f32 v44, v24, v25
    v_cvt_pk_bf16_f32 v45, v26, v27
    v_cvt_pk_bf16_f32 v46, v28, v29
    v_cvt_pk_bf16_f32 v47, v30, v31
    buffer_store_dwordx4 v[44:47], v3, s[20:23], s45 offen offset:1024
.Lmlpa_k_end_1:
    s_endpgm
.globl mlpb_kernel
.p2align 8
.type mlpb_kernel,@function
mlpb_kernel:
    s_cmp_ge_u32 s2, 256
    s_cbranch_scc1 .Lmlpb_k_end_1
    v_and_b32 v1, 63, v0
    v_lshrrev_b32 v2, 6, v0
    s_nop 0
    v_readfirstlane_b32 s3, v2
    s_load_dwordx2 s[8:9], s[0:1], 104
    s_load_dwordx2 s[12:13], s[0:1], 72
    s_load_dwordx2 s[16:17], s[0:1], 80
    s_load_dwordx2 s[20:21], s[0:1], 88
    s_load_dwordx2 s[24:25], s[0:1], 104
    s_waitcnt lgkmcnt(0)
    s_add_u32 s8, s8, 0x5600000
    s_addc_u32 s9, s9, 0
    s_and_b32 s9, s9, 0xffff
    s_mov_b32 s10, 0x200000
    s_mov_b32 s11, 0x20000
    s_and_b32 s13, s13, 0xffff
    s_mov_b32 s14, 0x700000
    s_mov_b32 s15, 0x20000
    s_and_b32 s17, s17, 0xffff
    s_mov_b32 s18, 0x1000
    s_mov_b32 s19, 0x20000
    s_and_b32 s21, s21, 0xffff
    s_mov_b32 s22, 0x200000
    s_mov_b32 s23, 0x20000
    s_add_u32 s24, s24, 0x5200000
    s_addc_u32 s25, s25, 0
    s_and_b32 s25, s25, 0xffff
    s_mov_b32 s26, 0x200000
    s_mov_b32 s27, 0x20000
    s_and_b32 s36, s2, 7
    s_mul_i32 s36, s36, 32
    s_lshr_b32 s37, s2, 3
    s_add_u32 s36, s36, s37
    s_lshr_b32 s37, s36, 3
    s_and_b32 s36, s36, 7
    s_lshr_b32 s40, s3, 2
    s_bfe_u32 s38, s3, 0x10001
    s_and_b32 s39, s3, 1
    v_lshlrev_b32 v3, 4, v1
    v_lshl_add_u32 v4, v2, 1, 0
    v_lshrrev_b32 v7, 3, v1
    v_and_b32 v8, 7, v1
    v_mul_u32_u24 v9, 8, v4
    v_add_u32 v7, v7, v9
    v_bfe_u32 v9, v7, 1, 1
    v_lshlrev_b32 v9, 2, v9
    v_xor_b32 v8, v8, v9
    v_lshlrev_b32 v8, 4, v8
    s_mov_b32 s60, 4096
    v_mul_lo_u32 v5, s60, v7
    v_add_u32 v5, v5, v8
    v_lshl_add_u32 v4, v2, 1, 1
    v_lshrrev_b32 v7, 3, v1
    v_and_b32 v8, 7, v1
    v_mul_u32_u24 v9, 8, v4
    v_add_u32 v7, v7, v9
    v_bfe_u32 v9, v7, 1, 1
    v_lshlrev_b32 v9, 2, v9
    v_xor_b32 v8, v8, v9
    v_lshlrev_b32 v8, 4, v8
    s_mov_b32 s60, 4096
    v_mul_lo_u32 v6, s60, v7
    v_add_u32 v6, v6, v8
    s_lshl_b32 s42, s37, 7
    s_lshr_b32 s45, s3, 2
    s_mul_i32 s45, s45, 114688
    s_and_b32 s46, s3, 3
    s_lshl_b32 s46, s46, 11
    s_add_u32 s45, s45, s46
    v_add_u32 v7, s45, v3
    s_mul_i32 s41, s36, 229376
    s_lshl_b32 s43, s3, 11
    s_add_u32 s44, s43, 16384
    v_bfe_u32 v10, v1, 2, 2
    v_lshrrev_b32 v11, 5, v1
    v_lshlrev_b32 v11, 2, v11
    v_add_u32 v11, v11, v10
    v_mul_u32_u24 v8, 128, v11
    v_lshrrev_b32 v10, 1, v10
    v_xor_b32 v10, 0, v10
    v_lshlrev_b32 v10, 6, v10
    v_add_u32 v8, v8, v10
    v_bfe_u32 v10, v1, 4, 1
    v_lshlrev_b32 v10, 5, v10
    v_add_u32 v8, v8, v10
    v_and_b32 v10, 3, v1
    v_lshlrev_b32 v10, 3, v10
    v_add_u32 v8, v8, v10
    s_lshl_b32 s45, s38, 6
    v_xor_b32 v8, s45, v8
    s_lshl_b32 s45, s40, 13
    s_add_u32 s45, s45, 16384
    v_add_u32 v8, s45, v8
    v_add_u32 v9, 0x10000, v8
    s_lshl_b32 s45, s39, 13
    s_lshl_b32 s46, s40, 12
    s_add_u32 s45, s45, s46
    v_add_u32 v10, s45, v3
    v_add_u32 v11, 0x10000, v10
    v_lshrrev_b32 v84, 5, v1
    v_and_b32 v85, 31, v1
    v_lshlrev_b32 v86, 1, v85
    s_lshl_b32 s45, s37, 7
    s_lshl_b32 s46, s38, 6
    s_add_u32 s45, s45, s46
    buffer_load_ushort v68, v86, s[16:19], s45 offen
    v_lshlrev_b32 v86, 10, v85
    v_lshl_add_u32 v86, v84, 3, v86
    s_lshl_b32 s47, s37, 16
    s_lshl_b32 s46, s38, 15
    s_add_u32 s47, s47, s46
    s_lshl_b32 s46, s36, 7
    s_add_u32 s47, s47, s46
    s_lshl_b32 s46, s39, 6
    s_add_u32 s47, s47, s46
    buffer_load_dwordx2 v[60:61], v86, s[24:27], s47 offen offset:0
    buffer_load_dwordx2 v[62:63], v86, s[24:27], s47 offen offset:16
    buffer_load_dwordx2 v[64:65], v86, s[24:27], s47 offen offset:32
    buffer_load_dwordx2 v[66:67], v86, s[24:27], s47 offen offset:48
    v_mov_b32 v12, 0
    v_mov_b32 v13, 0
    v_mov_b32 v14, 0
    v_mov_b32 v15, 0
    v_mov_b32 v16, 0
    v_mov_b32 v17, 0
    v_mov_b32 v18, 0
    v_mov_b32 v19, 0
    v_mov_b32 v20, 0
    v_mov_b32 v21, 0
    v_mov_b32 v22, 0
    v_mov_b32 v23, 0
    v_mov_b32 v24, 0
    v_mov_b32 v25, 0
    v_mov_b32 v26, 0
    v_mov_b32 v27, 0
    s_add_u32 m0, s43, 0x0
    s_nop 0
    buffer_load_dwordx4 v7, s[8:11], s41 offen offset:0 lds
    buffer_load_dwordx4 v7, s[8:11], s41 offen offset:1024 lds
    s_add_u32 m0, s44, 0x0
    s_nop 0
    buffer_load_dwordx4 v5, s[12:15], s42 offen lds
    s_add_u32 m0, s44, 0x400
    s_nop 0
    buffer_load_dwordx4 v6, s[12:15], s42 offen lds
    s_add_u32 s41, s41, 8192
    s_add_u32 s42, s42, 524288
    s_add_u32 m0, s43, 0x8000
    s_nop 0
    buffer_load_dwordx4 v7, s[8:11], s41 offen offset:0 lds
    buffer_load_dwordx4 v7, s[8:11], s41 offen offset:1024 lds
    s_add_u32 m0, s44, 0x8000
    s_nop 0
    buffer_load_dwordx4 v5, s[12:15], s42 offen lds
    s_add_u32 m0, s44, 0x8400
    s_nop 0
    buffer_load_dwordx4 v6, s[12:15], s42 offen lds
    s_add_u32 s41, s41, 8192
    s_add_u32 s42, s42, 524288
    s_add_u32 m0, s43, 0x10000
    s_nop 0
    buffer_load_dwordx4 v7, s[8:11], s41 offen offset:0 lds
    buffer_load_dwordx4 v7, s[8:11], s41 offen offset:1024 lds
    s_add_u32 m0, s44, 0x10000
    s_nop 0
    buffer_load_dwordx4 v5, s[12:15], s42 offen lds
    s_add_u32 m0, s44, 0x10400
    s_nop 0
    buffer_load_dwordx4 v6, s[12:15], s42 offen lds
    s_add_u32 s41, s41, 8192
    s_add_u32 s42, s42, 524288
    s_waitcnt vmcnt(8) lgkmcnt(0)
    s_barrier
    ds_read_b64_tr_b16 v[28:29], v8 offset:0
    ds_read_b64_tr_b16 v[30:31], v8 offset:1024
    ds_read_b128 v[32:35], v10 offset:0
    ds_read_b64_tr_b16 v[36:37], v8 offset:2048
    ds_read_b64_tr_b16 v[38:39], v8 offset:3072
    ds_read_b128 v[40:43], v10 offset:1024
    ds_read_b64_tr_b16 v[44:45], v8 offset:4096
    ds_read_b64_tr_b16 v[46:47], v8 offset:5120
    ds_read_b128 v[48:51], v10 offset:2048
    s_waitcnt lgkmcnt(6)
    v_mfma_f32_32x32x16_bf16 v[12:27], v[32:35], v[28:31], v[12:27]
    ds_read_b64_tr_b16 v[52:53], v8 offset:6144
    ds_read_b64_tr_b16 v[54:55], v8 offset:7168
    ds_read_b128 v[56:59], v10 offset:3072
    s_add_u32 m0, s43, 0x18000
    s_nop 0
    buffer_load_dwordx4 v7, s[8:11], s41 offen offset:0 lds
    buffer_load_dwordx4 v7, s[8:11], s41 offen offset:1024 lds
    s_add_u32 m0, s44, 0x18000
    s_nop 0
    buffer_load_dwordx4 v5, s[12:15], s42 offen lds
    s_add_u32 m0, s44, 0x18400
    s_nop 0
    buffer_load_dwordx4 v6, s[12:15], s42 offen lds
    s_add_u32 s41, s41, 8192
    s_add_u32 s42, s42, 524288
    s_waitcnt vmcnt(8) lgkmcnt(0)
    s_barrier
    v_mfma_f32_32x32x16_bf16 v[12:27], v[40:43], v[36:39], v[12:27]
    ds_read_b64_tr_b16 v[28:29], v8 offset:32768
    ds_read_b64_tr_b16 v[30:31], v8 offset:33792
    ds_read_b128 v[32:35], v10 offset:32768
    s_add_u32 m0, s43, 0x0
    s_nop 0
    buffer_load_dwordx4 v7, s[8:11], s41 offen offset:0 lds
    buffer_load_dwordx4 v7, s[8:11], s41 offen offset:1024 lds
    s_add_u32 m0, s44, 0x0
    s_nop 0
    s_waitcnt lgkmcnt(6)
    v_mfma_f32_32x32x16_bf16 v[12:27], v[48:51], v[44:47], v[12:27]
    ds_read_b64_tr_b16 v[36:37], v8 offset:34816
    ds_read_b64_tr_b16 v[38:39], v8 offset:35840
    ds_read_b128 v[40:43], v10 offset:33792
    buffer_load_dwordx4 v5, s[12:15], s42 offen lds
    s_add_u32 m0, s44, 0x400
    s_nop 0
    buffer_load_dwordx4 v6, s[12:15], s42 offen lds
    s_add_u32 s41, s41, 8192
    s_waitcnt lgkmcnt(6)
    v_mfma_f32_32x32x16_bf16 v[12:27], v[56:59], v[52:55], v[12:27]
    ds_read_b64_tr_b16 v[44:45], v8 offset:36864
    ds_read_b64_tr_b16 v[46:47], v8 offset:37888
    ds_read_b128 v[48:51], v10 offset:34816
    s_add_u32 s42, s42, 524288
    s_waitcnt lgkmcnt(6)
    v_mfma_f32_32x32x16_bf16 v[12:27], v[32:35], v[28:31], v[12:27]
    ds_read_b64_tr_b16 v[52:53], v8 offset:38912
    ds_read_b64_tr_b16 v[54:55], v8 offset:39936
    ds_read_b128 v[56:59], v10 offset:35840
    s_waitcnt vmcnt(8) lgkmcnt(0)
    s_barrier
    v_mfma_f32_32x32x16_bf16 v[12:27], v[40:43], v[36:39], v[12:27]
    ds_read_b64_tr_b16 v[28:29], v9 offset:0
    ds_read_b64_tr_b16 v[30:31], v9 offset:1024
    ds_read_b128 v[32:35], v11 offset:0
    s_add_u32 m0, s43, 0x8000
    s_nop 0
    buffer_load_dwordx4 v7, s[8:11], s41 offen offset:0 lds
    buffer_load_dwordx4 v7, s[8:11], s41 offen offset:1024 lds
    s_add_u32 m0, s44, 0x8000
    s_nop 0
    s_waitcnt lgkmcnt(6)
    v_mfma_f32_32x32x16_bf16 v[12:27], v[48:51], v[44:47], v[12:27]
    ds_read_b64_tr_b16 v[36:37], v9 offset:2048
    ds_read_b64_tr_b16 v[38:39], v9 offset:3072
    ds_read_b128 v[40:43], v11 offset:1024
    buffer_load_dwordx4 v5, s[12:15], s42 offen lds
    s_add_u32 m0, s44, 0x8400
    s_nop 0
    buffer_load_dwordx4 v6, s[12:15], s42 offen lds
    s_add_u32 s41, s41, 8192
    s_waitcnt lgkmcnt(6)
    v_mfma_f32_32x32x16_bf16 v[12:27], v[56:59], v[52:55], v[12:27]
    ds_read_b64_tr_b16 v[44:45], v9 offset:4096
    ds_read_b64_tr_b16 v[46:47], v9 offset:5120
    ds_read_b128 v[48:51], v11 offset:2048
    s_add_u32 s42, s42, 524288
    s_waitcnt lgkmcnt(6)
    v_mfma_f32_32x32x16_bf16 v[12:27], v[32:35], v[28:31], v[12:27]
    ds_read_b64_tr_b16 v[52:53], v9 offset:6144
    ds_read_b64_tr_b16 v[54:55], v9 offset:7168
    ds_read_b128 v[56:59], v11 offset:3072
    s_waitcnt vmcnt(8) lgkmcnt(0)
    s_barrier
    v_mfma_f32_32x32x16_bf16 v[12:27], v[40:43], v[36:39], v[12:27]
    ds_read_b64_tr_b16 v[28:29], v9 offset:32768
    ds_read_b64_tr_b16 v[30:31], v9 offset:33792
    ds_read_b128 v[32:35], v11 offset:32768
    s_add_u32 m0, s43, 0x10000
    s_nop 0
    buffer_load_dwordx4 v7, s[8:11], s41 offen offset:0 lds
    buffer_load_dwordx4 v7, s[8:11], s41 offen offset:1024 lds
    s_add_u32 m0, s44, 0x10000
    s_nop 0
    s_waitcnt lgkmcnt(6)
    v_mfma_f32_32x32x16_bf16 v[12:27], v[48:51], v[44:47], v[12:27]
    ds_read_b64_tr_b16 v[36:37], v9 offset:34816
    ds_read_b64_tr_b16 v[38:39], v9 offset:35840
    ds_read_b128 v[40:43], v11 offset:33792
    buffer_load_dwordx4 v5, s[12:15], s42 offen lds
    s_add_u32 m0, s44, 0x10400
    s_nop 0
    buffer_load_dwordx4 v6, s[12:15], s42 offen lds
    s_add_u32 s41, s41, 8192
    s_waitcnt lgkmcnt(6)
    v_mfma_f32_32x32x16_bf16 v[12:27], v[56:59], v[52:55], v[12:27]
    ds_read_b64_tr_b16 v[44:45], v9 offset:36864
    ds_read_b64_tr_b16 v[46:47], v9 offset:37888
    ds_read_b128 v[48:51], v11 offset:34816
    s_add_u32 s42, s42, 524288
    s_waitcnt lgkmcnt(6)
    v_mfma_f32_32x32x16_bf16 v[12:27], v[32:35], v[28:31], v[12:27]
    ds_read_b64_tr_b16 v[52:53], v9 offset:38912
    ds_read_b64_tr_b16 v[54:55], v9 offset:39936
    ds_read_b128 v[56:59], v11 offset:35840
    s_waitcnt vmcnt(8) lgkmcnt(0)
    s_barrier
    v_mfma_f32_32x32x16_bf16 v[12:27], v[40:43], v[36:39], v[12:27]
    ds_read_b64_tr_b16 v[28:29], v8 offset:0
    ds_read_b64_tr_b16 v[30:31], v8 offset:1024
    ds_read_b128 v[32:35], v10 offset:0
    s_add_u32 m0, s43, 0x18000
    s_nop 0
    buffer_load_dwordx4 v7, s[8:11], s41 offen offset:0 lds
    buffer_load_dwordx4 v7, s[8:11], s41 offen offset:1024 lds
    s_add_u32 m0, s44, 0x18000
    s_nop 0
    s_waitcnt lgkmcnt(6)
    v_mfma_f32_32x32x16_bf16 v[12:27], v[48:51], v[44:47], v[12:27]
    ds_read_b64_tr_b16 v[36:37], v8 offset:2048
    ds_read_b64_tr_b16 v[38:39], v8 offset:3072
    ds_read_b128 v[40:43], v10 offset:1024
    buffer_load_dwordx4 v5, s[12:15], s42 offen lds
    s_add_u32 m0, s44, 0x18400
    s_nop 0
    buffer_load_dwordx4 v6, s[12:15], s42 offen lds
    s_add_u32 s41, s41, 8192
    s_waitcnt lgkmcnt(6)
    v_mfma_f32_32x32x16_bf16 v[12:27], v[56:59], v[52:55], v[12:27]
    ds_read_b64_tr_b16 v[44:45], v8 offset:4096
    ds_read_b64_tr_b16 v[46:47], v8 offset:5120
    ds_read_b128 v[48:51], v10 offset:2048
    s_add_u32 s42, s42, 524288
    s_waitcnt lgkmcnt(6)
    v_mfma_f32_32x32x16_bf16 v[12:27], v[32:35], v[28:31], v[12:27]
    ds_read_b64_tr_b16 v[52:53], v8 offset:6144
    ds_read_b64_tr_b16 v[54:55], v8 offset:7168
    ds_read_b128 v[56:59], v10 offset:3072
    s_waitcnt vmcnt(8) lgkmcnt(0)
    s_barrier
    v_mfma_f32_32x32x16_bf16 v[12:27], v[40:43], v[36:39], v[12:27]
    ds_read_b64_tr_b16 v[28:29], v8 offset:32768
    ds_read_b64_tr_b16 v[30:31], v8 offset:33792
    ds_read_b128 v[32:35], v10 offset:32768
    s_add_u32 m0, s43, 0x0
    s_nop 0
    buffer_load_dwordx4 v7, s[8:11], s41 offen offset:0 lds
    buffer_load_dwordx4 v7, s[8:11], s41 offen offset:1024 lds
    s_add_u32 m0, s44, 0x0
    s_nop 0
    s_waitcnt lgkmcnt(6)
    v_mfma_f32_32x32x16_bf16 v[12:27], v[48:51], v[44:47], v[12:27]
    ds_read_b64_tr_b16 v[36:37], v8 offset:34816
    ds_read_b64_tr_b16 v[38:39], v8 offset:35840
    ds_read_b128 v[40:43], v10 offset:33792
    buffer_load_dwordx4 v5, s[12:15], s42 offen lds
    s_add_u32 m0, s44, 0x400
    s_nop 0
    buffer_load_dwordx4 v6, s[12:15], s42 offen lds
    s_add_u32 s41, s41, 8192
    s_waitcnt lgkmcnt(6)
    v_mfma_f32_32x32x16_bf16 v[12:27], v[56:59], v[52:55], v[12:27]
    ds_read_b64_tr_b16 v[44:45], v8 offset:36864
    ds_read_b64_tr_b16 v[46:47], v8 offset:37888
    ds_read_b128 v[48:51], v10 offset:34816
    s_add_u32 s42, s42, 524288
    s_waitcnt lgkmcnt(6)
    v_mfma_f32_32x32x16_bf16 v[12:27], v[32:35], v[28:31], v[12:27]
    ds_read_b64_tr_b16 v[52:53], v8 offset:38912
    ds_read_b64_tr_b16 v[54:55], v8 offset:39936
    ds_read_b128 v[56:59], v10 offset:35840
    s_waitcnt vmcnt(8) lgkmcnt(0)
    s_barrier
    v_mfma_f32_32x32x16_bf16 v[12:27], v[40:43], v[36:39], v[12:27]
    ds_read_b64_tr_b16 v[28:29], v9 offset:0
    ds_read_b64_tr_b16 v[30:31], v9 offset:1024
    ds_read_b128 v[32:35], v11 offset:0
    s_add_u32 m0, s43, 0x8000
    s_nop 0
    buffer_load_dwordx4 v7, s[8:11], s41 offen offset:0 lds
    buffer_load_dwordx4 v7, s[8:11], s41 offen offset:1024 lds
    s_add_u32 m0, s44, 0x8000
    s_nop 0
    s_waitcnt lgkmcnt(6)
    v_mfma_f32_32x32x16_bf16 v[12:27], v[48:51], v[44:47], v[12:27]
    ds_read_b64_tr_b16 v[36:37], v9 offset:2048
    ds_read_b64_tr_b16 v[38:39], v9 offset:3072
    ds_read_b128 v[40:43], v11 offset:1024
    buffer_load_dwordx4 v5, s[12:15], s42 offen lds
    s_add_u32 m0, s44, 0x8400
    s_nop 0
    buffer_load_dwordx4 v6, s[12:15], s42 offen lds
    s_add_u32 s41, s41, 8192
    s_waitcnt lgkmcnt(6)
    v_mfma_f32_32x32x16_bf16 v[12:27], v[56:59], v[52:55], v[12:27]
    ds_read_b64_tr_b16 v[44:45], v9 offset:4096
    ds_read_b64_tr_b16 v[46:47], v9 offset:5120
    ds_read_b128 v[48:51], v11 offset:2048
    s_add_u32 s42, s42, 524288
    s_waitcnt lgkmcnt(6)
    v_mfma_f32_32x32x16_bf16 v[12:27], v[32:35], v[28:31], v[12:27]
    ds_read_b64_tr_b16 v[52:53], v9 offset:6144
    ds_read_b64_tr_b16 v[54:55], v9 offset:7168
    ds_read_b128 v[56:59], v11 offset:3072
    s_waitcnt vmcnt(8) lgkmcnt(0)
    s_barrier
    v_mfma_f32_32x32x16_bf16 v[12:27], v[40:43], v[36:39], v[12:27]
    ds_read_b64_tr_b16 v[28:29], v9 offset:32768
    ds_read_b64_tr_b16 v[30:31], v9 offset:33792
    ds_read_b128 v[32:35], v11 offset:32768
    s_add_u32 m0, s43, 0x10000
    s_nop 0
    buffer_load_dwordx4 v7, s[8:11], s41 offen offset:0 lds
    buffer_load_dwordx4 v7, s[8:11], s41 offen offset:1024 lds
    s_add_u32 m0, s44, 0x10000
    s_nop 0
    s_waitcnt lgkmcnt(6)
    v_mfma_f32_32x32x16_bf16 v[12:27], v[48:51], v[44:47], v[12:27]
    ds_read_b64_tr_b16 v[36:37], v9 offset:34816
    ds_read_b64_tr_b16 v[38:39], v9 offset:35840
    ds_read_b128 v[40:43], v11 offset:33792
    buffer_load_dwordx4 v5, s[12:15], s42 offen lds
    s_add_u32 m0, s44, 0x10400
    s_nop 0
    buffer_load_dwordx4 v6, s[12:15], s42 offen lds
    s_add_u32 s41, s41, 8192
    s_waitcnt lgkmcnt(6)
    v_mfma_f32_32x32x16_bf16 v[12:27], v[56:59], v[52:55], v[12:27]
    ds_read_b64_tr_b16 v[44:45], v9 offset:36864
    ds_read_b64_tr_b16 v[46:47], v9 offset:37888
    ds_read_b128 v[48:51], v11 offset:34816
    s_add_u32 s42, s42, 524288
    s_waitcnt lgkmcnt(6)
    v_mfma_f32_32x32x16_bf16 v[12:27], v[32:35], v[28:31], v[12:27]
    ds_read_b64_tr_b16 v[52:53], v9 offset:38912
    ds_read_b64_tr_b16 v[54:55], v9 offset:39936
    ds_read_b128 v[56:59], v11 offset:35840
    s_waitcnt vmcnt(8) lgkmcnt(0)
    s_barrier
    v_mfma_f32_32x32x16_bf16 v[12:27], v[40:43], v[36:39], v[12:27]
    ds_read_b64_tr_b16 v[28:29], v8 offset:0
    ds_read_b64_tr_b16 v[30:31], v8 offset:1024
    ds_read_b128 v[32:35], v10 offset:0
    s_add_u32 m0, s43, 0x18000
    s_nop 0
    buffer_load_dwordx4 v7, s[8:11], s41 offen offset:0 lds
    buffer_load_dwordx4 v7, s[8:11], s41 offen offset:1024 lds
    s_add_u32 m0, s44, 0x18000
    s_nop 0
    s_waitcnt lgkmcnt(6)
    v_mfma_f32_32x32x16_bf16 v[12:27], v[48:51], v[44:47], v[12:27]
    ds_read_b64_tr_b16 v[36:37], v8 offset:2048
    ds_read_b64_tr_b16 v[38:39], v8 offset:3072
    ds_read_b128 v[40:43], v10 offset:1024
    buffer_load_dwordx4 v5, s[12:15], s42 offen lds
    s_add_u32 m0, s44, 0x18400
    s_nop 0
    buffer_load_dwordx4 v6, s[12:15], s42 offen lds
    s_add_u32 s41, s41, 8192
    s_waitcnt lgkmcnt(6)
    v_mfma_f32_32x32x16_bf16 v[12:27], v[56:59], v[52:55], v[12:27]
    ds_read_b64_tr_b16 v[44:45], v8 offset:4096
    ds_read_b64_tr_b16 v[46:47], v8 offset:5120
    ds_read_b128 v[48:51], v10 offset:2048
    s_add_u32 s42, s42, 524288
    s_waitcnt lgkmcnt(6)
    v_mfma_f32_32x32x16_bf16 v[12:27], v[32:35], v[28:31], v[12:27]
    ds_read_b64_tr_b16 v[52:53], v8 offset:6144
    ds_read_b64_tr_b16 v[54:55], v8 offset:7168
    ds_read_b128 v[56:59], v10 offset:3072
    s_waitcnt vmcnt(8) lgkmcnt(0)
    s_barrier
    v_mfma_f32_32x32x16_bf16 v[12:27], v[40:43], v[36:39], v[12:27]
    ds_read_b64_tr_b16 v[28:29], v8 offset:32768
    ds_read_b64_tr_b16 v[30:31], v8 offset:33792
    ds_read_b128 v[32:35], v10 offset:32768
    s_add_u32 m0, s43, 0x0
    s_nop 0
    buffer_load_dwordx4 v7, s[8:11], s41 offen offset:0 lds
    buffer_load_dwordx4 v7, s[8:11], s41 offen offset:1024 lds
    s_add_u32 m0, s44, 0x0
    s_nop 0
    s_waitcnt lgkmcnt(6)
    v_mfma_f32_32x32x16_bf16 v[12:27], v[48:51], v[44:47], v[12:27]
    ds_read_b64_tr_b16 v[36:37], v8 offset:34816
    ds_read_b64_tr_b16 v[38:39], v8 offset:35840
    ds_read_b128 v[40:43], v10 offset:33792
    buffer_load_dwordx4 v5, s[12:15], s42 offen lds
    s_add_u32 m0, s44, 0x400
    s_nop 0
    buffer_load_dwordx4 v6, s[12:15], s42 offen lds
    s_add_u32 s41, s41, 8192
    s_waitcnt lgkmcnt(6)
    v_mfma_f32_32x32x16_bf16 v[12:27], v[56:59], v[52:55], v[12:27]
    ds_read_b64_tr_b16 v[44:45], v8 offset:36864
    ds_read_b64_tr_b16 v[46:47], v8 offset:37888
    ds_read_b128 v[48:51], v10 offset:34816
    s_add_u32 s42, s42, 524288
    s_waitcnt lgkmcnt(6)
    v_mfma_f32_32x32x16_bf16 v[12:27], v[32:35], v[28:31], v[12:27]
    ds_read_b64_tr_b16 v[52:53], v8 offset:38912
    ds_read_b64_tr_b16 v[54:55], v8 offset:39936
    ds_read_b128 v[56:59], v10 offset:35840
    s_waitcnt vmcnt(8) lgkmcnt(0)
    s_barrier
    v_mfma_f32_32x32x16_bf16 v[12:27], v[40:43], v[36:39], v[12:27]
    ds_read_b64_tr_b16 v[28:29], v9 offset:0
    ds_read_b64_tr_b16 v[30:31], v9 offset:1024
    ds_read_b128 v[32:35], v11 offset:0
    s_add_u32 m0, s43, 0x8000
    s_nop 0
    buffer_load_dwordx4 v7, s[8:11], s41 offen offset:0 lds
    buffer_load_dwordx4 v7, s[8:11], s41 offen offset:1024 lds
    s_add_u32 m0, s44, 0x8000
    s_nop 0
    s_waitcnt lgkmcnt(6)
    v_mfma_f32_32x32x16_bf16 v[12:27], v[48:51], v[44:47], v[12:27]
    ds_read_b64_tr_b16 v[36:37], v9 offset:2048
    ds_read_b64_tr_b16 v[38:39], v9 offset:3072
    ds_read_b128 v[40:43], v11 offset:1024
    buffer_load_dwordx4 v5, s[12:15], s42 offen lds
    s_add_u32 m0, s44, 0x8400
    s_nop 0
    buffer_load_dwordx4 v6, s[12:15], s42 offen lds
    s_add_u32 s41, s41, 8192
    s_waitcnt lgkmcnt(6)
    v_mfma_f32_32x32x16_bf16 v[12:27], v[56:59], v[52:55], v[12:27]
    ds_read_b64_tr_b16 v[44:45], v9 offset:4096
    ds_read_b64_tr_b16 v[46:47], v9 offset:5120
    ds_read_b128 v[48:51], v11 offset:2048
    s_add_u32 s42, s42, 524288
    s_waitcnt lgkmcnt(6)
    v_mfma_f32_32x32x16_bf16 v[12:27], v[32:35], v[28:31], v[12:27]
    ds_read_b64_tr_b16 v[52:53], v9 offset:6144
    ds_read_b64_tr_b16 v[54:55], v9 offset:7168
    ds_read_b128 v[56:59], v11 offset:3072
    s_waitcnt vmcnt(8) lgkmcnt(0)
    s_barrier
    v_mfma_f32_32x32x16_bf16 v[12:27], v[40:43], v[36:39], v[12:27]
    ds_read_b64_tr_b16 v[28:29], v9 offset:32768
    ds_read_b64_tr_b16 v[30:31], v9 offset:33792
    ds_read_b128 v[32:35], v11 offset:32768
    s_waitcnt lgkmcnt(6)
    v_mfma_f32_32x32x16_bf16 v[12:27], v[48:51], v[44:47], v[12:27]
    ds_read_b64_tr_b16 v[36:37], v9 offset:34816
    ds_read_b64_tr_b16 v[38:39], v9 offset:35840
    ds_read_b128 v[40:43], v11 offset:33792
    s_waitcnt lgkmcnt(6)
    v_mfma_f32_32x32x16_bf16 v[12:27], v[56:59], v[52:55], v[12:27]
    ds_read_b64_tr_b16 v[44:45], v9 offset:36864
    ds_read_b64_tr_b16 v[46:47], v9 offset:37888
    ds_read_b128 v[48:51], v11 offset:34816
    s_waitcnt lgkmcnt(6)
    v_mfma_f32_32x32x16_bf16 v[12:27], v[32:35], v[28:31], v[12:27]
    ds_read_b64_tr_b16 v[52:53], v9 offset:38912
    ds_read_b64_tr_b16 v[54:55], v9 offset:39936
    ds_read_b128 v[56:59], v11 offset:35840
    s_waitcnt vmcnt(4) lgkmcnt(0)
    s_barrier
    v_mfma_f32_32x32x16_bf16 v[12:27], v[40:43], v[36:39], v[12:27]
    ds_read_b64_tr_b16 v[28:29], v8 offset:0
    ds_read_b64_tr_b16 v[30:31], v8 offset:1024
    ds_read_b128 v[32:35], v10 offset:0
    s_waitcnt lgkmcnt(6)
    v_mfma_f32_32x32x16_bf16 v[12:27], v[48:51], v[44:47], v[12:27]
    ds_read_b64_tr_b16 v[36:37], v8 offset:2048
    ds_read_b64_tr_b16 v[38:39], v8 offset:3072
    ds_read_b128 v[40:43], v10 offset:1024
    s_waitcnt lgkmcnt(6)
    v_mfma_f32_32x32x16_bf16 v[12:27], v[56:59], v[52:55], v[12:27]
    ds_read_b64_tr_b16 v[44:45], v8 offset:4096
    ds_read_b64_tr_b16 v[46:47], v8 offset:5120
    ds_read_b128 v[48:51], v10 offset:2048
    s_waitcnt lgkmcnt(6)
    v_mfma_f32_32x32x16_bf16 v[12:27], v[32:35], v[28:31], v[12:27]
    ds_read_b64_tr_b16 v[52:53], v8 offset:6144
    ds_read_b64_tr_b16 v[54:55], v8 offset:7168
    ds_read_b128 v[56:59], v10 offset:3072
    s_waitcnt vmcnt(0) lgkmcnt(0)
    s_barrier
    v_mfma_f32_32x32x16_bf16 v[12:27], v[40:43], v[36:39], v[12:27]
    ds_read_b64_tr_b16 v[28:29], v8 offset:32768
    ds_read_b64_tr_b16 v[30:31], v8 offset:33792
    ds_read_b128 v[32:35], v10 offset:32768
    s_waitcnt lgkmcnt(6)
    v_mfma_f32_32x32x16_bf16 v[12:27], v[48:51], v[44:47], v[12:27]
    ds_read_b64_tr_b16 v[36:37], v8 offset:34816
    ds_read_b64_tr_b16 v[38:39], v8 offset:35840
    ds_read_b128 v[40:43], v10 offset:33792
    s_waitcnt lgkmcnt(6)
    v_mfma_f32_32x32x16_bf16 v[12:27], v[56:59], v[52:55], v[12:27]
    ds_read_b64_tr_b16 v[44:45], v8 offset:36864
    ds_read_b64_tr_b16 v[46:47], v8 offset:37888
    ds_read_b128 v[48:51], v10 offset:34816
    s_waitcnt lgkmcnt(6)
    v_mfma_f32_32x32x16_bf16 v[12:27], v[32:35], v[28:31], v[12:27]
    ds_read_b64_tr_b16 v[52:53], v8 offset:38912
    ds_read_b64_tr_b16 v[54:55], v8 offset:39936
    ds_read_b128 v[56:59], v10 offset:35840
    s_waitcnt lgkmcnt(6)
    v_mfma_f32_32x32x16_bf16 v[12:27], v[40:43], v[36:39], v[12:27]
    s_waitcnt lgkmcnt(3)
    v_mfma_f32_32x32x16_bf16 v[12:27], v[48:51], v[44:47], v[12:27]
    s_waitcnt lgkmcnt(0)
    v_mfma_f32_32x32x16_bf16 v[12:27], v[56:59], v[52:55], v[12:27]
    s_nop 11
    s_and_b32 s45, s3, 3
    s_lshl_b32 s45, s45, 12
    s_add_u32 s45, s45, 98304
    v_add_u32 v28, s45, v3
    s_cmp_eq_u32 s40, 0
    s_cbranch_scc1 .Lmlpb_k_ks0_3
    ds_write_b128 v28, v[12:15] offset:0
    ds_write_b128 v28, v[16:19] offset:1024
    ds_write_b128 v28, v[20:23] offset:2048
    ds_write_b128 v28, v[24:27] offset:3072
    s_waitcnt lgkmcnt(0)
    s_barrier
    s_branch .Lmlpb_k_end_1
.Lmlpb_k_ks0_3:
    s_barrier
    ds_read_b128 v[36:39], v28 offset:0
    ds_read_b128 v[40:43], v28 offset:1024
    ds_read_b128 v[44:47], v28 offset:2048
    ds_read_b128 v[48:51], v28 offset:3072
    s_waitcnt lgkmcnt(0)
    v_add_f32 v12, v12, v36
    v_add_f32 v13, v13, v37
    v_add_f32 v14, v14, v38
    v_add_f32 v15, v15, v39
    v_add_f32 v16, v16, v40
    v_add_f32 v17, v17, v41
    v_add_f32 v18, v18, v42
    v_add_f32 v19, v19, v43
    v_add_f32 v20, v20, v44
    v_add_f32 v21, v21, v45
    v_add_f32 v22, v22, v46
    v_add_f32 v23, v23, v47
    v_add_f32 v24, v24, v48
    v_add_f32 v25, v25, v49
    v_add_f32 v26, v26, v50
    v_add_f32 v27, v27, v51
    v_lshlrev_b32 v36, 16, v68
    v_add_f32 v12, v12, v36
    v_add_f32 v13, v13, v36
    v_add_f32 v14, v14, v36
    v_add_f32 v15, v15, v36
    v_add_f32 v16, v16, v36
    v_add_f32 v17, v17, v36
    v_add_f32 v18, v18, v36
    v_add_f32 v19, v19, v36
    v_add_f32 v20, v20, v36
    v_add_f32 v21, v21, v36
    v_add_f32 v22, v22, v36
    v_add_f32 v23, v23, v36
    v_add_f32 v24, v24, v36
    v_add_f32 v25, v25, v36
    v_add_f32 v26, v26, v36
    v_add_f32 v27, v27, v36
    v_lshlrev_b32 v68, 16, v60
    v_and_b32 v69, 0xffff0000, v60
    v_lshlrev_b32 v70, 16, v61
    v_and_b32 v71, 0xffff0000, v61
    v_lshlrev_b32 v72, 16, v62
    v_and_b32 v73, 0xffff0000, v62
    v_lshlrev_b32 v74, 16, v63
    v_and_b32 v75, 0xffff0000, v63
    v_lshlrev_b32 v76, 16, v64
    v_and_b32 v77, 0xffff0000, v64
    v_lshlrev_b32 v78, 16, v65
    v_and_b32 v79, 0xffff0000, v65
    v_lshlrev_b32 v80, 16, v66
    v_and_b32 v81, 0xffff0000, v66
    v_lshlrev_b32 v82, 16, v67
    v_and_b32 v83, 0xffff0000, v67
    v_add_f32 v12, v12, v68
    v_add_f32 v13, v13, v69
    v_add_f32 v14, v14, v70
    v_add_f32 v15, v15, v71
    v_add_f32 v16, v16, v72
    v_add_f32 v17, v17, v73
    v_add_f32 v18, v18, v74
    v_add_f32 v19, v19, v75
    v_add_f32 v20, v20, v76
    v_add_f32 v21, v21, v77
    v_add_f32 v22, v22, v78
    v_add_f32 v23, v23, v79
    v_add_f32 v24, v24, v80
    v_add_f32 v25, v25, v81
    v_add_f32 v26, v26, v82
    v_add_f32 v27, v27, v83
    v_lshl_add_u32 v86, v84, 3, v86
    v_cvt_pk_bf16_f32 v36, v12, v13
    v_cvt_pk_bf16_f32 v37, v14, v15
    v_cvt_pk_bf16_f32 v38, v16, v17
    v_cvt_pk_bf16_f32 v39, v18, v19
    s_nop 1
    v_permlane32_swap_b32 v36, v38
    v_permlane32_swap_b32 v37, v39
    s_nop 1
    buffer_store_dwordx4 v[36:39], v86, s[20:23], s47 offen offset:0
    v_cvt_pk_bf16_f32 v40, v20, v21
    v_cvt_pk_bf16_f32 v41, v22, v23
    v_cvt_pk_bf16_f32 v42, v24, v25
    v_cvt_pk_bf16_f32 v43, v26, v27
    s_nop 1
    v_permlane32_swap_b32 v40, v42
    v_permlane32_swap_b32 v41, v43
    s_nop 1
    buffer_store_dwordx4 v[40:43], v86, s[20:23], s47 offen offset:32
.Lmlpb_k_end_1:
    s_endpgm
.section .rodata,"a"
.p2align 6
.amdhsa_kernel kvproj_kernel
  .amdhsa_next_free_vgpr 224
  .amdhsa_next_free_sgpr 96
  .amdhsa_accum_offset 224
  .amdhsa_group_segment_fixed_size 0
  .amdhsa_kernarg_size 112
  .amdhsa_user_sgpr_count 2
  .amdhsa_user_sgpr_kernarg_segment_ptr 1
  .amdhsa_system_sgpr_workgroup_id_x 1
.end_amdhsa_kernel
.p2align 6
.amdhsa_kernel attn_kernel
  .amdhsa_next_free_vgpr 216
  .amdhsa_next_free_sgpr 96
  .amdhsa_accum_offset 216
  .amdhsa_group_segment_fixed_size 0
  .amdhsa_kernarg_size 112
  .amdhsa_user_sgpr_count 2
  .amdhsa_user_sgpr_kernarg_segment_ptr 1
  .amdhsa_system_sgpr_workgroup_id_x 1
.end_amdhsa_kernel
.p2align 6
.amdhsa_kernel oproj_kernel
  .amdhsa_next_free_vgpr 88
  .amdhsa_next_free_sgpr 96
  .amdhsa_accum_offset 88
  .amdhsa_group_segment_fixed_size 0
  .amdhsa_kernarg_size 112
  .amdhsa_user_sgpr_count 2
  .amdhsa_user_sgpr_kernarg_segment_ptr 1
  .amdhsa_system_sgpr_workgroup_id_x 1
.end_amdhsa_kernel
.p2align 6
.amdhsa_kernel red_kernel
  .amdhsa_next_free_vgpr 72
  .amdhsa_next_free_sgpr 96
  .amdhsa_accum_offset 72
  .amdhsa_group_segment_fixed_size 0
  .amdhsa_kernarg_size 112
  .amdhsa_user_sgpr_count 2
  .amdhsa_user_sgpr_kernarg_segment_ptr 1
  .amdhsa_system_sgpr_workgroup_id_x 1
.end_amdhsa_kernel
.p2align 6
.amdhsa_kernel mlpa_kernel
  .amdhsa_next_free_vgpr 96
  .amdhsa_next_free_sgpr 96
  .amdhsa_accum_offset 96
  .amdhsa_group_segment_fixed_size 0
  .amdhsa_kernarg_size 112
  .amdhsa_user_sgpr_count 2
  .amdhsa_user_sgpr_kernarg_segment_ptr 1
  .amdhsa_system_sgpr_workgroup_id_x 1
.end_amdhsa_kernel
.p2align 6
.amdhsa_kernel mlpb_kernel
  .amdhsa_next_free_vgpr 88
  .amdhsa_next_free_sgpr 96
  .amdhsa_accum_offset 88
  .amdhsa_group_segment_fixed_size 0
  .amdhsa_kernarg_size 112
  .amdhsa_user_sgpr_count 2
  .amdhsa_user_sgpr_kernarg_segment_ptr 1
  .amdhsa_system_sgpr_workgroup_id_x 1
.end_amdhsa_kernel
```
